```python
import torch

def _softmax(x, axis=-1):
    return torch.softmax(x, dim=axis)

def _gelu(x):
    return torch.nn.functional.gelu(x, approximate='tanh')

def _silu(x):
    return torch.nn.functional.silu(x)

def _sigmoid(x):
    return torch.sigmoid(x)

def _layernorm(x, axis=-1, eps=1e-05):
    m = x.mean(dim=axis, keepdim=True)
    v = x.var(dim=axis, keepdim=True, unbiased=False)
    return (x - m) / torch.sqrt(v + eps)

def _scatter_add(tgt, idx, src, axis=0):
    return tgt.clone().index_add_(axis, idx, src)

def _segment_sum(src, seg, n):
    out = torch.zeros((n,) + src.shape[1:], dtype=src.dtype)
    return out.index_add_(0, seg, src)

def _pad(x, pw):
    flat = tuple((v for pair in reversed(pw) for v in pair))
    return torch.nn.functional.pad(x, flat)
kernel_name = 'standalone__autoregressive_conv_wavenet__speech'

def setup_inputs():

    _w = lambda a: (lambda t: t.to(torch.bfloat16) if t.is_floating_point() else t)(torch.as_tensor(a))
    B, T, D, K = (2, 4000, 256, 31)
    return {'x': _w((lambda *s: torch.randn(*s, dtype=torch.bfloat16) * 0.1)(B, T, D)), 'w': _w((lambda *s: torch.randn(*s, dtype=torch.bfloat16) * 0.1)(K, D, 2 * D)), 'w_o': _w((lambda *s: torch.randn(*s, dtype=torch.bfloat16) * 0.05)(D, D))}

def reference(x, w, w_o):
    B, T, D = x.shape
    K = w.shape[0]
    dil = 2
    pad = (K - 1) * dil
    xp = _pad(x, ((0, 0), (pad, 0), (0, 0)))
    h = torch.einsum('btc,cd->btd', xp[:, pad:pad + T, :], w[0])
    for i in range(1, K):
        off = pad - i * dil
        h = h + torch.einsum('btc,cd->btd', xp[:, off:off + T, :], w[i])
    f = h[..., :D].clone()
    g = h[..., D:].clone()
    z = torch.tanh(f) * _sigmoid(g)
    return z @ w_o
```

```asm
; @launch grid=(256,1,1) block=(512,1,1) lds=163840
.amdgcn_target "amdgcn-amd-amdhsa--gfx950"
.text
.globl standalone__autoregressive_conv_wavenet__speech_kernel
.p2align 8
.type standalone__autoregressive_conv_wavenet__speech_kernel,@function
standalone__autoregressive_conv_wavenet__speech_kernel:
    s_cmp_ge_u32 s2, 256
    s_cbranch_scc1 L_end
    s_load_dwordx4 s[4:7], s[0:1], 0
    s_load_dwordx4 s[8:11], s[0:1], 16
    s_load_dwordx4 s[12:15], s[0:1], 32
    s_getpc_b64 s[44:45]
L_pcref:
    s_sub_u32 s44, s44, L_pcref-standalone__autoregressive_conv_wavenet__speech_kernel
    s_subb_u32 s45, s45, 0
    v_lshlrev_b32 v11, 6, v0
    v_min_u32 v11, L_end-standalone__autoregressive_conv_wavenet__speech_kernel, v11
    global_load_dword v250, v11, s[44:45]
    v_lshrrev_b32 v1, 6, v0
    v_and_b32 v5, 63, v0
    v_readfirstlane_b32 s30, v1
    s_and_b32 s29, s2, 7
    s_lshl_b32 s29, s29, 2
    s_lshr_b32 s28, s2, 3
    s_lshr_b32 s35, s28, 3
    s_add_u32 s29, s29, s35
    s_and_b32 s28, s28, 7
    s_and_b32 s31, s29, 7
    s_lshl_b32 s31, s31, 7
    s_lshr_b32 s32, s29, 3
    s_and_b32 s33, s32, 1
    s_lshr_b32 s34, s32, 1
    v_mov_b32 v84, 0
    v_mov_b32 v85, 0
    s_mov_b32 s36, 0xffff0000
    s_mov_b32 s91, 0x00003f80
    s_mov_b32 s92, 0x3f800000
    s_mov_b32 s37, 32768
    s_mul_i32 s35, s34, 2048000
    s_and_b32 s40, s30, 3
    s_cmp_ge_u32 s30, 4
    s_cbranch_scc1 L_prod
    v_lshrrev_b32 v11, 3, v5
    v_and_b32 v12, 7, v5
    s_lshl_b32 s44, s33, 9
    s_lshl_b32 s42, s30, 3
    s_add_u32 s42, s42, s31
    s_sub_u32 s42, s42, 16
    v_add_u32 v14, s42, v11
    v_lshl_add_u32 v8, v12, 4, s44
    v_lshl_add_u32 v15, v14, 11, v8
    v_cmp_gt_i32 s[46:47], 0, v14
    v_cmp_gt_i32 s[48:49], 1, v14
    v_add_u32 v113, 0x10000, v15
    v_add_u32 v10, 0xfffffc00, v15
    v_mov_b32 v9, 0x40000000
    v_add_u32 v112, 0xfc00, v15
    v_cndmask_b32 v111, v15, v9, s[46:47]
    v_cndmask_b32 v110, v10, v9, s[48:49]
    v_and_b32 v7, 3, v12
    v_lshrrev_b32 v6, 2, v12
    v_lshlrev_b32 v6, 15, v6
    v_mul_u32_u24 v10, 1216, v11
    s_lshl_b32 s41, s30, 6
    v_add3_u32 v6, v6, v10, s41
    v_lshl_add_u32 v120, v7, 4, v6
    v_xor_b32 v7, 2, v7
    v_lshl_add_u32 v121, v7, 4, v6
    s_cmp_ge_u32 s30, 2
    s_cselect_b32 s41, 0x40000000, 196608
    s_waitcnt lgkmcnt(0)
    s_add_u32 s16, s4, s35
    s_addc_u32 s17, s5, 0
    s_mov_b32 s18, 2048000
    s_mov_b32 s19, 0x20000
    buffer_load_dwordx4 v[16:19], v110, s[16:19], 0 offen
    buffer_load_dwordx4 v[20:23], v111, s[16:19], 0 offen
    buffer_load_dwordx4 v[24:27], v111, s[16:19], 0 offen offset:1024
    buffer_load_dwordx4 v[28:31], v112, s[16:19], 0 offen
    buffer_load_dwordx4 v[32:35], v113, s[16:19], 0 offen
    buffer_load_dwordx4 v[36:39], v113, s[16:19], 0 offen offset:1024
    s_mov_b32 s42, 0x10000
    buffer_load_dwordx4 v[40:43], v112, s[16:19], s42 offen
    buffer_load_dwordx4 v[44:47], v113, s[16:19], s42 offen
    buffer_load_dwordx4 v[48:51], v113, s[16:19], s42 offen offset:1024
    s_mov_b32 s43, 0x20000
    buffer_load_dwordx4 v[52:55], v112, s[16:19], s43 offen
    buffer_load_dwordx4 v[56:59], v113, s[16:19], s43 offen
    buffer_load_dwordx4 v[60:63], v113, s[16:19], s43 offen offset:1024
    buffer_load_dwordx4 v[64:67], v112, s[16:19], s41 offen
    buffer_load_dwordx4 v[68:71], v113, s[16:19], s41 offen
    buffer_load_dwordx4 v[72:75], v113, s[16:19], s41 offen offset:1024
    s_mov_b32 s20, s6
    s_mov_b32 s21, s7
    s_mov_b32 s22, 8126464
    s_mov_b32 s23, 0x20000
    s_mov_b32 s24, s14
    s_mov_b32 s25, s15
    s_mov_b32 s26, 16777216
    s_mov_b32 s27, 0x20000
    v_mov_b32 v136, 0
    v_mov_b32 v137, 0
    v_mov_b32 v138, 0
    v_mov_b32 v139, 0
    v_mov_b32 v140, 0
    v_mov_b32 v141, 0
    v_mov_b32 v142, 0
    v_mov_b32 v143, 0
    v_mov_b32 v144, 0
    v_mov_b32 v145, 0
    v_mov_b32 v146, 0
    v_mov_b32 v147, 0
    v_mov_b32 v148, 0
    v_mov_b32 v149, 0
    v_mov_b32 v150, 0
    v_mov_b32 v151, 0
    v_mov_b32 v152, 0
    v_mov_b32 v153, 0
    v_mov_b32 v154, 0
    v_mov_b32 v155, 0
    v_mov_b32 v156, 0
    v_mov_b32 v157, 0
    v_mov_b32 v158, 0
    v_mov_b32 v159, 0
    v_mov_b32 v160, 0
    v_mov_b32 v161, 0
    v_mov_b32 v162, 0
    v_mov_b32 v163, 0
    v_mov_b32 v164, 0
    v_mov_b32 v165, 0
    v_mov_b32 v166, 0
    v_mov_b32 v167, 0
    v_mov_b32 v168, 0
    v_mov_b32 v169, 0
    v_mov_b32 v170, 0
    v_mov_b32 v171, 0
    v_mov_b32 v172, 0
    v_mov_b32 v173, 0
    v_mov_b32 v174, 0
    v_mov_b32 v175, 0
    v_mov_b32 v176, 0
    v_mov_b32 v177, 0
    v_mov_b32 v178, 0
    v_mov_b32 v179, 0
    v_mov_b32 v180, 0
    v_mov_b32 v181, 0
    v_mov_b32 v182, 0
    v_mov_b32 v183, 0
    v_mov_b32 v184, 0
    v_mov_b32 v185, 0
    v_mov_b32 v186, 0
    v_mov_b32 v187, 0
    v_mov_b32 v188, 0
    v_mov_b32 v189, 0
    v_mov_b32 v190, 0
    v_mov_b32 v191, 0
    v_mov_b32 v192, 0
    v_mov_b32 v193, 0
    v_mov_b32 v194, 0
    v_mov_b32 v195, 0
    v_mov_b32 v196, 0
    v_mov_b32 v197, 0
    v_mov_b32 v198, 0
    v_mov_b32 v199, 0
    v_mov_b32 v200, 0
    v_mov_b32 v201, 0
    v_mov_b32 v202, 0
    v_mov_b32 v203, 0
    v_mov_b32 v204, 0
    v_mov_b32 v205, 0
    v_mov_b32 v206, 0
    v_mov_b32 v207, 0
    v_mov_b32 v208, 0
    v_mov_b32 v209, 0
    v_mov_b32 v210, 0
    v_mov_b32 v211, 0
    v_mov_b32 v212, 0
    v_mov_b32 v213, 0
    v_mov_b32 v214, 0
    v_mov_b32 v215, 0
    v_mov_b32 v216, 0
    v_mov_b32 v217, 0
    v_mov_b32 v218, 0
    v_mov_b32 v219, 0
    v_mov_b32 v220, 0
    v_mov_b32 v221, 0
    v_mov_b32 v222, 0
    v_mov_b32 v223, 0
    v_mov_b32 v224, 0
    v_mov_b32 v225, 0
    v_mov_b32 v226, 0
    v_mov_b32 v227, 0
    v_mov_b32 v228, 0
    v_mov_b32 v229, 0
    v_mov_b32 v230, 0
    v_mov_b32 v231, 0
    s_waitcnt vmcnt(12)
    v_lshlrev_b32 v88, 16, v20
    v_and_b32 v89, s36, v20
    v_lshlrev_b32 v90, 16, v24
    v_and_b32 v91, s36, v24
    v_lshlrev_b32 v92, 16, v16
    v_and_b32 v93, s36, v16
    v_sub_f32 v90, v90, v88
    v_sub_f32 v91, v91, v89
    v_sub_f32 v92, v92, v88
    v_sub_f32 v93, v93, v89
    v_cvt_pk_bf16_f32 v104, v90, v91
    v_cvt_pk_bf16_f32 v100, v92, v93
    v_lshlrev_b32 v94, 16, v21
    v_and_b32 v95, s36, v21
    v_lshlrev_b32 v96, 16, v25
    v_and_b32 v97, s36, v25
    v_lshlrev_b32 v98, 16, v17
    v_and_b32 v99, s36, v17
    v_sub_f32 v96, v96, v94
    v_sub_f32 v97, v97, v95
    v_sub_f32 v98, v98, v94
    v_sub_f32 v99, v99, v95
    v_cvt_pk_bf16_f32 v105, v96, v97
    v_cvt_pk_bf16_f32 v101, v98, v99
    v_lshlrev_b32 v88, 16, v22
    v_and_b32 v89, s36, v22
    v_lshlrev_b32 v90, 16, v26
    v_and_b32 v91, s36, v26
    v_lshlrev_b32 v92, 16, v18
    v_and_b32 v93, s36, v18
    v_sub_f32 v90, v90, v88
    v_sub_f32 v91, v91, v89
    v_sub_f32 v92, v92, v88
    v_sub_f32 v93, v93, v89
    v_cvt_pk_bf16_f32 v106, v90, v91
    v_cvt_pk_bf16_f32 v102, v92, v93
    v_lshlrev_b32 v94, 16, v23
    v_and_b32 v95, s36, v23
    v_lshlrev_b32 v96, 16, v27
    v_and_b32 v97, s36, v27
    v_lshlrev_b32 v98, 16, v19
    v_and_b32 v99, s36, v19
    v_sub_f32 v96, v96, v94
    v_sub_f32 v97, v97, v95
    v_sub_f32 v98, v98, v94
    v_sub_f32 v99, v99, v95
    v_cvt_pk_bf16_f32 v107, v96, v97
    v_cvt_pk_bf16_f32 v103, v98, v99
    ds_write_b128 v120, v[100:103] offset:0
    ds_write_b128 v120, v[104:107] offset:9728
    ds_write_b128 v120, v[20:23] offset:19456
    s_waitcnt vmcnt(9)
    v_lshlrev_b32 v88, 16, v32
    v_and_b32 v89, s36, v32
    v_lshlrev_b32 v90, 16, v36
    v_and_b32 v91, s36, v36
    v_lshlrev_b32 v92, 16, v28
    v_and_b32 v93, s36, v28
    v_sub_f32 v90, v90, v88
    v_sub_f32 v91, v91, v89
    v_sub_f32 v92, v92, v88
    v_sub_f32 v93, v93, v89
    v_cvt_pk_bf16_f32 v132, v90, v91
    v_cvt_pk_bf16_f32 v128, v92, v93
    v_lshlrev_b32 v94, 16, v33
    v_and_b32 v95, s36, v33
    v_lshlrev_b32 v96, 16, v37
    v_and_b32 v97, s36, v37
    v_lshlrev_b32 v98, 16, v29
    v_and_b32 v99, s36, v29
    v_sub_f32 v96, v96, v94
    v_sub_f32 v97, v97, v95
    v_sub_f32 v98, v98, v94
    v_sub_f32 v99, v99, v95
    v_cvt_pk_bf16_f32 v133, v96, v97
    v_cvt_pk_bf16_f32 v129, v98, v99
    v_lshlrev_b32 v88, 16, v34
    v_and_b32 v89, s36, v34
    v_lshlrev_b32 v90, 16, v38
    v_and_b32 v91, s36, v38
    v_lshlrev_b32 v92, 16, v30
    v_and_b32 v93, s36, v30
    v_sub_f32 v90, v90, v88
    v_sub_f32 v91, v91, v89
    v_sub_f32 v92, v92, v88
    v_sub_f32 v93, v93, v89
    v_cvt_pk_bf16_f32 v134, v90, v91
    v_cvt_pk_bf16_f32 v130, v92, v93
    v_lshlrev_b32 v94, 16, v35
    v_and_b32 v95, s36, v35
    v_lshlrev_b32 v96, 16, v39
    v_and_b32 v97, s36, v39
    v_lshlrev_b32 v98, 16, v31
    v_and_b32 v99, s36, v31
    v_sub_f32 v96, v96, v94
    v_sub_f32 v97, v97, v95
    v_sub_f32 v98, v98, v94
    v_sub_f32 v99, v99, v95
    v_cvt_pk_bf16_f32 v135, v96, v97
    v_cvt_pk_bf16_f32 v131, v98, v99
    ds_write_b128 v121, v[128:131] offset:256
    ds_write_b128 v121, v[132:135] offset:9984
    ds_write_b128 v121, v[32:35] offset:19712
    s_waitcnt vmcnt(6)
    v_lshlrev_b32 v88, 16, v44
    v_and_b32 v89, s36, v44
    v_lshlrev_b32 v90, 16, v48
    v_and_b32 v91, s36, v48
    v_lshlrev_b32 v92, 16, v40
    v_and_b32 v93, s36, v40
    v_sub_f32 v90, v90, v88
    v_sub_f32 v91, v91, v89
    v_sub_f32 v92, v92, v88
    v_sub_f32 v93, v93, v89
    v_cvt_pk_bf16_f32 v104, v90, v91
    v_cvt_pk_bf16_f32 v100, v92, v93
    v_lshlrev_b32 v94, 16, v45
    v_and_b32 v95, s36, v45
    v_lshlrev_b32 v96, 16, v49
    v_and_b32 v97, s36, v49
    v_lshlrev_b32 v98, 16, v41
    v_and_b32 v99, s36, v41
    v_sub_f32 v96, v96, v94
    v_sub_f32 v97, v97, v95
    v_sub_f32 v98, v98, v94
    v_sub_f32 v99, v99, v95
    v_cvt_pk_bf16_f32 v105, v96, v97
    v_cvt_pk_bf16_f32 v101, v98, v99
    v_lshlrev_b32 v88, 16, v46
    v_and_b32 v89, s36, v46
    v_lshlrev_b32 v90, 16, v50
    v_and_b32 v91, s36, v50
    v_lshlrev_b32 v92, 16, v42
    v_and_b32 v93, s36, v42
    v_sub_f32 v90, v90, v88
    v_sub_f32 v91, v91, v89
    v_sub_f32 v92, v92, v88
    v_sub_f32 v93, v93, v89
    v_cvt_pk_bf16_f32 v106, v90, v91
    v_cvt_pk_bf16_f32 v102, v92, v93
    v_lshlrev_b32 v94, 16, v47
    v_and_b32 v95, s36, v47
    v_lshlrev_b32 v96, 16, v51
    v_and_b32 v97, s36, v51
    v_lshlrev_b32 v98, 16, v43
    v_and_b32 v99, s36, v43
    v_sub_f32 v96, v96, v94
    v_sub_f32 v97, v97, v95
    v_sub_f32 v98, v98, v94
    v_sub_f32 v99, v99, v95
    v_cvt_pk_bf16_f32 v107, v96, v97
    v_cvt_pk_bf16_f32 v103, v98, v99
    ds_write_b128 v120, v[100:103] offset:512
    ds_write_b128 v120, v[104:107] offset:10240
    ds_write_b128 v120, v[44:47] offset:19968
    s_waitcnt vmcnt(3)
    v_lshlrev_b32 v88, 16, v56
    v_and_b32 v89, s36, v56
    v_lshlrev_b32 v90, 16, v60
    v_and_b32 v91, s36, v60
    v_lshlrev_b32 v92, 16, v52
    v_and_b32 v93, s36, v52
    v_sub_f32 v90, v90, v88
    v_sub_f32 v91, v91, v89
    v_sub_f32 v92, v92, v88
    v_sub_f32 v93, v93, v89
    v_cvt_pk_bf16_f32 v132, v90, v91
    v_cvt_pk_bf16_f32 v128, v92, v93
    v_lshlrev_b32 v94, 16, v57
    v_and_b32 v95, s36, v57
    v_lshlrev_b32 v96, 16, v61
    v_and_b32 v97, s36, v61
    v_lshlrev_b32 v98, 16, v53
    v_and_b32 v99, s36, v53
    v_sub_f32 v96, v96, v94
    v_sub_f32 v97, v97, v95
    v_sub_f32 v98, v98, v94
    v_sub_f32 v99, v99, v95
    v_cvt_pk_bf16_f32 v133, v96, v97
    v_cvt_pk_bf16_f32 v129, v98, v99
    v_lshlrev_b32 v88, 16, v58
    v_and_b32 v89, s36, v58
    v_lshlrev_b32 v90, 16, v62
    v_and_b32 v91, s36, v62
    v_lshlrev_b32 v92, 16, v54
    v_and_b32 v93, s36, v54
    v_sub_f32 v90, v90, v88
    v_sub_f32 v91, v91, v89
    v_sub_f32 v92, v92, v88
    v_sub_f32 v93, v93, v89
    v_cvt_pk_bf16_f32 v134, v90, v91
    v_cvt_pk_bf16_f32 v130, v92, v93
    v_lshlrev_b32 v94, 16, v59
    v_and_b32 v95, s36, v59
    v_lshlrev_b32 v96, 16, v63
    v_and_b32 v97, s36, v63
    v_lshlrev_b32 v98, 16, v55
    v_and_b32 v99, s36, v55
    v_sub_f32 v96, v96, v94
    v_sub_f32 v97, v97, v95
    v_sub_f32 v98, v98, v94
    v_sub_f32 v99, v99, v95
    v_cvt_pk_bf16_f32 v135, v96, v97
    v_cvt_pk_bf16_f32 v131, v98, v99
    ds_write_b128 v121, v[128:131] offset:768
    ds_write_b128 v121, v[132:135] offset:10496
    ds_write_b128 v121, v[56:59] offset:20224
    s_cmp_ge_u32 s30, 2
    s_cbranch_scc1 L_pj
    s_waitcnt vmcnt(0)
    v_lshlrev_b32 v88, 16, v68
    v_and_b32 v89, s36, v68
    v_lshlrev_b32 v90, 16, v72
    v_and_b32 v91, s36, v72
    v_lshlrev_b32 v92, 16, v64
    v_and_b32 v93, s36, v64
    v_sub_f32 v90, v90, v88
    v_sub_f32 v91, v91, v89
    v_sub_f32 v92, v92, v88
    v_sub_f32 v93, v93, v89
    v_cvt_pk_bf16_f32 v104, v90, v91
    v_cvt_pk_bf16_f32 v100, v92, v93
    v_lshlrev_b32 v94, 16, v69
    v_and_b32 v95, s36, v69
    v_lshlrev_b32 v96, 16, v73
    v_and_b32 v97, s36, v73
    v_lshlrev_b32 v98, 16, v65
    v_and_b32 v99, s36, v65
    v_sub_f32 v96, v96, v94
    v_sub_f32 v97, v97, v95
    v_sub_f32 v98, v98, v94
    v_sub_f32 v99, v99, v95
    v_cvt_pk_bf16_f32 v105, v96, v97
    v_cvt_pk_bf16_f32 v101, v98, v99
    v_lshlrev_b32 v88, 16, v70
    v_and_b32 v89, s36, v70
    v_lshlrev_b32 v90, 16, v74
    v_and_b32 v91, s36, v74
    v_lshlrev_b32 v92, 16, v66
    v_and_b32 v93, s36, v66
    v_sub_f32 v90, v90, v88
    v_sub_f32 v91, v91, v89
    v_sub_f32 v92, v92, v88
    v_sub_f32 v93, v93, v89
    v_cvt_pk_bf16_f32 v106, v90, v91
    v_cvt_pk_bf16_f32 v102, v92, v93
    v_lshlrev_b32 v94, 16, v71
    v_and_b32 v95, s36, v71
    v_lshlrev_b32 v96, 16, v75
    v_and_b32 v97, s36, v75
    v_lshlrev_b32 v98, 16, v67
    v_and_b32 v99, s36, v67
    v_sub_f32 v96, v96, v94
    v_sub_f32 v97, v97, v95
    v_sub_f32 v98, v98, v94
    v_sub_f32 v99, v99, v95
    v_cvt_pk_bf16_f32 v107, v96, v97
    v_cvt_pk_bf16_f32 v103, v98, v99
    ds_write_b128 v120, v[100:103] offset:1024
    ds_write_b128 v120, v[104:107] offset:10752
    ds_write_b128 v120, v[68:71] offset:20480
L_pj:
    v_and_b32 v6, 15, v5
    v_lshrrev_b32 v7, 4, v5
    v_add_u32 v8, 0, v6
    v_lshrrev_b32 v8, 1, v8
    v_and_b32 v8, 2, v8
    v_xor_b32 v8, v8, v7
    v_lshlrev_b32 v8, 4, v8
    v_lshl_add_u32 v1, v6, 6, v8
    v_add_u32 v8, 1, v6
    v_lshrrev_b32 v8, 1, v8
    v_and_b32 v8, 2, v8
    v_xor_b32 v8, v8, v7
    v_lshlrev_b32 v8, 4, v8
    v_lshl_add_u32 v2, v6, 6, v8
    v_add_u32 v8, 2, v6
    v_lshrrev_b32 v8, 1, v8
    v_and_b32 v8, 2, v8
    v_xor_b32 v8, v8, v7
    v_lshlrev_b32 v8, 4, v8
    v_lshl_add_u32 v3, v6, 6, v8
    v_lshrrev_b32 v8, 2, v6
    v_and_b32 v9, 3, v6
    v_lshrrev_b32 v10, 1, v8
    v_and_b32 v10, 1, v10
    v_and_b32 v11, 1, v7
    v_lshl_or_b32 v10, v11, 1, v10
    v_xor_b32 v10, s30, v10
    v_lshlrev_b32 v10, 5, v10
    v_lshl_add_u32 v11, v7, 3, v8
    v_lshl_add_u32 v10, v11, 7, v10
    v_lshl_add_u32 v10, v9, 3, v10
    v_add_u32 v4, 65536, v10
    v_mov_b32 v248, 30720
    s_waitcnt vmcnt(0) lgkmcnt(0)
    s_barrier
    ds_read_b64_tr_b16 v[232:233], v4 offset:0
    ds_read_b64_tr_b16 v[234:235], v4 offset:512
    ds_read_b64_tr_b16 v[236:237], v4 offset:4096
    ds_read_b64_tr_b16 v[238:239], v4 offset:4608
    ds_read_b128 v[68:71], v3 offset:8640
    ds_read_b128 v[64:67], v3 offset:7424
    ds_read_b128 v[60:63], v3 offset:6208
    ds_read_b128 v[56:59], v3 offset:4992
    ds_read_b128 v[52:55], v3 offset:3776
    ds_read_b128 v[48:51], v3 offset:2560
    ds_read_b128 v[44:47], v3 offset:1344
    ds_read_b128 v[40:43], v3 offset:128
    ds_read_b64_tr_b16 v[28:29], v4 offset:8192
    ds_read_b64_tr_b16 v[30:31], v4 offset:8704
    ds_read_b64_tr_b16 v[32:33], v4 offset:12288
    ds_read_b64_tr_b16 v[34:35], v4 offset:12800
    ds_read_b128 v[100:103], v3 offset:18368
    ds_read_b128 v[96:99], v3 offset:17152
    ds_read_b128 v[92:95], v3 offset:15936
    ds_read_b128 v[88:91], v3 offset:14720
    ds_read_b128 v[84:87], v3 offset:13504
    ds_read_b128 v[80:83], v3 offset:12288
    ds_read_b128 v[76:79], v3 offset:11072
    ds_read_b128 v[72:75], v3 offset:9856
    ds_read_b128 v[132:135], v3 offset:28096
    ds_read_b128 v[128:131], v3 offset:26880
    ds_read_b128 v[124:127], v3 offset:25664
    ds_read_b128 v[120:123], v3 offset:24448
    ds_read_b128 v[116:119], v3 offset:23232
    ds_read_b128 v[112:115], v3 offset:22016
    ds_read_b128 v[108:111], v3 offset:20800
    ds_read_b128 v[104:107], v3 offset:19584
    s_waitcnt lgkmcnt(15)
    v_lshlrev_b32 v8, 16, v232
    v_lshlrev_b32 v9, 16, v236
    v_and_b32 v10, s36, v232
    v_and_b32 v11, s36, v236
    v_add_f32 v8, v8, v9
    v_add_f32 v10, v10, v11
    v_cvt_pk_bf16_f32 v240, v8, v10
    v_lshlrev_b32 v12, 16, v233
    v_lshlrev_b32 v13, 16, v237
    v_and_b32 v14, s36, v233
    v_and_b32 v15, s36, v237
    v_add_f32 v12, v12, v13
    v_add_f32 v14, v14, v15
    v_cvt_pk_bf16_f32 v241, v12, v14
    v_lshlrev_b32 v8, 16, v234
    v_lshlrev_b32 v9, 16, v238
    v_and_b32 v10, s36, v234
    v_and_b32 v11, s36, v238
    v_add_f32 v8, v8, v9
    v_add_f32 v10, v10, v11
    v_cvt_pk_bf16_f32 v242, v8, v10
    v_lshlrev_b32 v12, 16, v235
    v_lshlrev_b32 v13, 16, v239
    v_and_b32 v14, s36, v235
    v_and_b32 v15, s36, v239
    v_add_f32 v12, v12, v13
    v_add_f32 v14, v14, v15
    v_cvt_pk_bf16_f32 v243, v12, v14
    s_waitcnt lgkmcnt(0)
    s_mov_b32 s38, 8
L_cloop:
    v_mfma_f32_16x16x32_bf16 v[164:167], v[232:235], v[68:71], v[164:167]
    s_barrier
    ds_read_b128 v[68:71], v2 offset:8576
    v_mfma_f32_16x16x32_bf16 v[160:163], v[232:235], v[64:67], v[160:163]
    v_xor_b32 v3, s37, v3
    s_waitcnt lgkmcnt(5)
    v_lshlrev_b32 v8, 16, v28
    v_mfma_f32_16x16x32_bf16 v[156:159], v[232:235], v[60:63], v[156:159]
    v_lshlrev_b32 v9, 16, v32
    v_mfma_f32_16x16x32_bf16 v[152:155], v[232:235], v[56:59], v[152:155]
    v_and_b32 v10, s36, v28
    v_mfma_f32_16x16x32_bf16 v[148:151], v[232:235], v[52:55], v[148:151]
    v_and_b32 v11, s36, v32
    v_add_f32 v8, v8, v9
    v_mfma_f32_16x16x32_bf16 v[144:147], v[232:235], v[48:51], v[144:147]
    v_add_f32 v10, v10, v11
    v_mfma_f32_16x16x32_bf16 v[140:143], v[232:235], v[44:47], v[140:143]
    v_cvt_pk_bf16_f32 v36, v8, v10
    v_lshlrev_b32 v12, 16, v29
    v_mfma_f32_16x16x32_bf16 v[136:139], v[232:235], v[40:43], v[136:139]
    v_lshlrev_b32 v13, 16, v33
    v_mfma_f32_16x16x32_bf16 v[196:199], v[236:239], v[100:103], v[196:199]
    ds_read_b128 v[100:103], v2 offset:18304
    v_and_b32 v14, s36, v29
    v_mfma_f32_16x16x32_bf16 v[192:195], v[236:239], v[96:99], v[192:195]
    ds_read_b64_tr_b16 v[16:17], v4 offset:16384
    v_and_b32 v15, s36, v33
    v_mfma_f32_16x16x32_bf16 v[188:191], v[236:239], v[92:95], v[188:191]
    ds_read_b64_tr_b16 v[18:19], v4 offset:16896
    v_mfma_f32_16x16x32_bf16 v[184:187], v[236:239], v[88:91], v[184:187]
    v_add_f32 v12, v12, v13
    v_add_f32 v14, v14, v15
    v_mfma_f32_16x16x32_bf16 v[180:183], v[236:239], v[84:87], v[180:183]
    v_cvt_pk_bf16_f32 v37, v12, v14
    v_mfma_f32_16x16x32_bf16 v[176:179], v[236:239], v[80:83], v[176:179]
    v_lshlrev_b32 v8, 16, v30
    v_mfma_f32_16x16x32_bf16 v[172:175], v[236:239], v[76:79], v[172:175]
    v_lshlrev_b32 v9, 16, v34
    v_and_b32 v10, s36, v30
    v_mfma_f32_16x16x32_bf16 v[168:171], v[236:239], v[72:75], v[168:171]
    v_and_b32 v11, s36, v34
    v_mfma_f32_16x16x32_bf16 v[228:231], v[240:243], v[132:135], v[228:231]
    ds_read_b128 v[132:135], v2 offset:28032
    v_add_f32 v8, v8, v9
    v_mfma_f32_16x16x32_bf16 v[224:227], v[240:243], v[128:131], v[224:227]
    ds_read_b64_tr_b16 v[20:21], v4 offset:20480
    v_add_f32 v10, v10, v11
    v_mfma_f32_16x16x32_bf16 v[220:223], v[240:243], v[124:127], v[220:223]
    ds_read_b64_tr_b16 v[22:23], v4 offset:20992
    s_waitcnt lgkmcnt(10)
    v_mfma_f32_16x16x32_bf16 v[216:219], v[240:243], v[120:123], v[216:219]
    v_cvt_pk_bf16_f32 v38, v8, v10
    v_lshlrev_b32 v12, 16, v31
    s_waitcnt lgkmcnt(9)
    v_mfma_f32_16x16x32_bf16 v[212:215], v[240:243], v[116:119], v[212:215]
    v_lshlrev_b32 v13, 16, v35
    s_waitcnt lgkmcnt(8)
    v_mfma_f32_16x16x32_bf16 v[208:211], v[240:243], v[112:115], v[208:211]
    v_and_b32 v14, s36, v31
    v_and_b32 v15, s36, v35
    s_waitcnt lgkmcnt(7)
    v_mfma_f32_16x16x32_bf16 v[204:207], v[240:243], v[108:111], v[204:207]
    v_add_f32 v12, v12, v13
    v_mfma_f32_16x16x32_bf16 v[200:203], v[240:243], v[104:107], v[200:203]
    v_add_f32 v14, v14, v15
    v_cvt_pk_bf16_f32 v39, v12, v14
    v_mfma_f32_16x16x32_bf16 v[164:167], v[28:31], v[64:67], v[164:167]
    s_barrier
    ds_read_b128 v[64:67], v2 offset:7360
    v_mfma_f32_16x16x32_bf16 v[160:163], v[28:31], v[60:63], v[160:163]
    s_waitcnt lgkmcnt(1)
    v_lshlrev_b32 v8, 16, v16
    v_lshlrev_b32 v9, 16, v20
    v_mfma_f32_16x16x32_bf16 v[156:159], v[28:31], v[56:59], v[156:159]
    v_and_b32 v10, s36, v16
    v_mfma_f32_16x16x32_bf16 v[152:155], v[28:31], v[52:55], v[152:155]
    v_and_b32 v11, s36, v20
    v_mfma_f32_16x16x32_bf16 v[148:151], v[28:31], v[48:51], v[148:151]
    v_add_f32 v8, v8, v9
    v_add_f32 v10, v10, v11
    v_mfma_f32_16x16x32_bf16 v[144:147], v[28:31], v[44:47], v[144:147]
    v_cvt_pk_bf16_f32 v24, v8, v10
    v_mfma_f32_16x16x32_bf16 v[140:143], v[28:31], v[40:43], v[140:143]
    v_lshlrev_b32 v12, 16, v17
    v_mfma_f32_16x16x32_bf16 v[136:139], v[28:31], v[68:71], v[136:139]
    v_lshlrev_b32 v13, 16, v21
    v_and_b32 v14, s36, v17
    v_mfma_f32_16x16x32_bf16 v[196:199], v[32:35], v[96:99], v[196:199]
    ds_read_b128 v[96:99], v2 offset:17088
    v_mfma_f32_16x16x32_bf16 v[192:195], v[32:35], v[92:95], v[192:195]
    ds_read_b64_tr_b16 v[28:29], v4 offset:24576
    v_and_b32 v15, s36, v21
    v_mfma_f32_16x16x32_bf16 v[188:191], v[32:35], v[88:91], v[188:191]
    ds_read_b64_tr_b16 v[30:31], v4 offset:25088
    v_add_f32 v12, v12, v13
    v_mfma_f32_16x16x32_bf16 v[184:187], v[32:35], v[84:87], v[184:187]
    v_add_f32 v14, v14, v15
    v_mfma_f32_16x16x32_bf16 v[180:183], v[32:35], v[80:83], v[180:183]
    v_cvt_pk_bf16_f32 v25, v12, v14
    v_lshlrev_b32 v8, 16, v18
    v_mfma_f32_16x16x32_bf16 v[176:179], v[32:35], v[76:79], v[176:179]
    v_lshlrev_b32 v9, 16, v22
    v_mfma_f32_16x16x32_bf16 v[172:175], v[32:35], v[72:75], v[172:175]
    v_and_b32 v10, s36, v18
    v_mfma_f32_16x16x32_bf16 v[168:171], v[32:35], v[100:103], v[168:171]
    v_and_b32 v11, s36, v22
    v_add_f32 v8, v8, v9
    v_mfma_f32_16x16x32_bf16 v[228:231], v[36:39], v[128:131], v[228:231]
    ds_read_b128 v[128:131], v2 offset:26816
    v_mfma_f32_16x16x32_bf16 v[224:227], v[36:39], v[124:127], v[224:227]
    ds_read_b64_tr_b16 v[32:33], v4 offset:28672
    v_add_f32 v10, v10, v11
    v_mfma_f32_16x16x32_bf16 v[220:223], v[36:39], v[120:123], v[220:223]
    ds_read_b64_tr_b16 v[34:35], v4 offset:29184
    v_cvt_pk_bf16_f32 v26, v8, v10
    v_mfma_f32_16x16x32_bf16 v[216:219], v[36:39], v[116:119], v[216:219]
    v_lshlrev_b32 v12, 16, v19
    v_mfma_f32_16x16x32_bf16 v[212:215], v[36:39], v[112:115], v[212:215]
    v_lshlrev_b32 v13, 16, v23
    v_mfma_f32_16x16x32_bf16 v[208:211], v[36:39], v[108:111], v[208:211]
    v_and_b32 v14, s36, v19
    v_and_b32 v15, s36, v23
    v_mfma_f32_16x16x32_bf16 v[204:207], v[36:39], v[104:107], v[204:207]
    v_add_f32 v12, v12, v13
    v_mfma_f32_16x16x32_bf16 v[200:203], v[36:39], v[132:135], v[200:203]
    v_add_f32 v14, v14, v15
    v_cvt_pk_bf16_f32 v27, v12, v14
    v_mfma_f32_16x16x32_bf16 v[164:167], v[16:19], v[60:63], v[164:167]
    s_barrier
    ds_read_b128 v[60:63], v2 offset:6144
    v_mfma_f32_16x16x32_bf16 v[160:163], v[16:19], v[56:59], v[160:163]
    s_waitcnt lgkmcnt(1)
    v_lshlrev_b32 v8, 16, v28
    v_lshlrev_b32 v9, 16, v32
    v_mfma_f32_16x16x32_bf16 v[156:159], v[16:19], v[52:55], v[156:159]
    v_and_b32 v10, s36, v28
    v_mfma_f32_16x16x32_bf16 v[152:155], v[16:19], v[48:51], v[152:155]
    v_and_b32 v11, s36, v32
    v_mfma_f32_16x16x32_bf16 v[148:151], v[16:19], v[44:47], v[148:151]
    v_add_f32 v8, v8, v9
    v_add_f32 v10, v10, v11
    v_mfma_f32_16x16x32_bf16 v[144:147], v[16:19], v[40:43], v[144:147]
    v_cvt_pk_bf16_f32 v36, v8, v10
    v_mfma_f32_16x16x32_bf16 v[140:143], v[16:19], v[68:71], v[140:143]
    v_lshlrev_b32 v12, 16, v29
    v_lshlrev_b32 v13, 16, v33
    v_mfma_f32_16x16x32_bf16 v[136:139], v[16:19], v[64:67], v[136:139]
    v_and_b32 v14, s36, v29
    v_mfma_f32_16x16x32_bf16 v[196:199], v[20:23], v[92:95], v[196:199]
    ds_read_b128 v[92:95], v2 offset:15872
    v_and_b32 v15, s36, v33
    v_mfma_f32_16x16x32_bf16 v[192:195], v[20:23], v[88:91], v[192:195]
    ds_read_b64_tr_b16 v[16:17], v4 offset:32768
    v_mfma_f32_16x16x32_bf16 v[188:191], v[20:23], v[84:87], v[188:191]
    ds_read_b64_tr_b16 v[18:19], v4 offset:33280
    v_add_f32 v12, v12, v13
    v_mfma_f32_16x16x32_bf16 v[184:187], v[20:23], v[80:83], v[184:187]
    v_add_f32 v14, v14, v15
    v_cvt_pk_bf16_f32 v37, v12, v14
    v_mfma_f32_16x16x32_bf16 v[180:183], v[20:23], v[76:79], v[180:183]
    ds_read_b64 v[246:247], v248
    v_mfma_f32_16x16x32_bf16 v[176:179], v[20:23], v[72:75], v[176:179]
    v_lshlrev_b32 v8, 16, v30
    v_lshlrev_b32 v9, 16, v34
    v_mfma_f32_16x16x32_bf16 v[172:175], v[20:23], v[100:103], v[172:175]
    v_and_b32 v10, s36, v30
    v_mfma_f32_16x16x32_bf16 v[168:171], v[20:23], v[96:99], v[168:171]
    v_and_b32 v11, s36, v34
    v_mfma_f32_16x16x32_bf16 v[228:231], v[24:27], v[124:127], v[228:231]
    ds_read_b128 v[124:127], v2 offset:25600
    v_add_f32 v8, v8, v9
    v_mfma_f32_16x16x32_bf16 v[224:227], v[24:27], v[120:123], v[224:227]
    ds_read_b64_tr_b16 v[20:21], v4 offset:36864
    v_add_f32 v10, v10, v11
    v_mfma_f32_16x16x32_bf16 v[220:223], v[24:27], v[116:119], v[220:223]
    ds_read_b64_tr_b16 v[22:23], v4 offset:37376
    v_cvt_pk_bf16_f32 v38, v8, v10
    v_mfma_f32_16x16x32_bf16 v[216:219], v[24:27], v[112:115], v[216:219]
    v_lshlrev_b32 v12, 16, v31
    v_mfma_f32_16x16x32_bf16 v[212:215], v[24:27], v[108:111], v[212:215]
    v_lshlrev_b32 v13, 16, v35
    v_mfma_f32_16x16x32_bf16 v[208:211], v[24:27], v[104:107], v[208:211]
    v_and_b32 v14, s36, v31
    v_and_b32 v15, s36, v35
    v_mfma_f32_16x16x32_bf16 v[204:207], v[24:27], v[132:135], v[204:207]
    v_add_f32 v12, v12, v13
    v_mfma_f32_16x16x32_bf16 v[200:203], v[24:27], v[128:131], v[200:203]
    v_add_f32 v14, v14, v15
    v_cvt_pk_bf16_f32 v39, v12, v14
    v_mfma_f32_16x16x32_bf16 v[164:167], v[28:31], v[56:59], v[164:167]
    s_barrier
    ds_read_b128 v[56:59], v2 offset:4928
    v_mfma_f32_16x16x32_bf16 v[160:163], v[28:31], v[52:55], v[160:163]
    s_waitcnt lgkmcnt(1)
    v_lshlrev_b32 v8, 16, v16
    v_lshlrev_b32 v9, 16, v20
    v_mfma_f32_16x16x32_bf16 v[156:159], v[28:31], v[48:51], v[156:159]
    v_and_b32 v10, s36, v16
    v_mfma_f32_16x16x32_bf16 v[152:155], v[28:31], v[44:47], v[152:155]
    v_and_b32 v11, s36, v20
    v_mfma_f32_16x16x32_bf16 v[148:151], v[28:31], v[40:43], v[148:151]
    v_add_f32 v8, v8, v9
    v_add_f32 v10, v10, v11
    v_mfma_f32_16x16x32_bf16 v[144:147], v[28:31], v[68:71], v[144:147]
    v_cvt_pk_bf16_f32 v24, v8, v10
    v_mfma_f32_16x16x32_bf16 v[140:143], v[28:31], v[64:67], v[140:143]
    v_lshlrev_b32 v12, 16, v17
    v_mfma_f32_16x16x32_bf16 v[136:139], v[28:31], v[60:63], v[136:139]
    v_lshlrev_b32 v13, 16, v21
    v_and_b32 v14, s36, v17
    v_mfma_f32_16x16x32_bf16 v[196:199], v[32:35], v[88:91], v[196:199]
    ds_read_b128 v[88:91], v2 offset:14656
    v_mfma_f32_16x16x32_bf16 v[192:195], v[32:35], v[84:87], v[192:195]
    ds_read_b64_tr_b16 v[28:29], v4 offset:40960
    v_and_b32 v15, s36, v21
    v_mfma_f32_16x16x32_bf16 v[188:191], v[32:35], v[80:83], v[188:191]
    ds_read_b64_tr_b16 v[30:31], v4 offset:41472
    v_add_f32 v12, v12, v13
    v_mfma_f32_16x16x32_bf16 v[184:187], v[32:35], v[76:79], v[184:187]
    v_add_f32 v14, v14, v15
    v_mfma_f32_16x16x32_bf16 v[180:183], v[32:35], v[72:75], v[180:183]
    v_cvt_pk_bf16_f32 v25, v12, v14
    v_lshlrev_b32 v8, 16, v18
    v_mfma_f32_16x16x32_bf16 v[176:179], v[32:35], v[100:103], v[176:179]
    v_lshlrev_b32 v9, 16, v22
    v_mfma_f32_16x16x32_bf16 v[172:175], v[32:35], v[96:99], v[172:175]
    v_and_b32 v10, s36, v18
    v_mfma_f32_16x16x32_bf16 v[168:171], v[32:35], v[92:95], v[168:171]
    v_and_b32 v11, s36, v22
    v_add_f32 v8, v8, v9
    v_mfma_f32_16x16x32_bf16 v[228:231], v[36:39], v[120:123], v[228:231]
    ds_read_b128 v[120:123], v2 offset:24384
    v_mfma_f32_16x16x32_bf16 v[224:227], v[36:39], v[116:119], v[224:227]
    ds_read_b64_tr_b16 v[32:33], v4 offset:45056
    v_add_f32 v10, v10, v11
    v_mfma_f32_16x16x32_bf16 v[220:223], v[36:39], v[112:115], v[220:223]
    ds_read_b64_tr_b16 v[34:35], v4 offset:45568
    v_cvt_pk_bf16_f32 v26, v8, v10
    v_mfma_f32_16x16x32_bf16 v[216:219], v[36:39], v[108:111], v[216:219]
    v_lshlrev_b32 v12, 16, v19
    v_mfma_f32_16x16x32_bf16 v[212:215], v[36:39], v[104:107], v[212:215]
    v_lshlrev_b32 v13, 16, v23
    v_mfma_f32_16x16x32_bf16 v[208:211], v[36:39], v[132:135], v[208:211]
    v_and_b32 v14, s36, v19
    v_and_b32 v15, s36, v23
    v_mfma_f32_16x16x32_bf16 v[204:207], v[36:39], v[128:131], v[204:207]
    v_add_f32 v12, v12, v13
    v_mfma_f32_16x16x32_bf16 v[200:203], v[36:39], v[124:127], v[200:203]
    v_add_f32 v14, v14, v15
    v_cvt_pk_bf16_f32 v27, v12, v14
    v_mfma_f32_16x16x32_bf16 v[164:167], v[16:19], v[52:55], v[164:167]
    s_barrier
    ds_read_b128 v[52:55], v2 offset:3712
    v_mfma_f32_16x16x32_bf16 v[160:163], v[16:19], v[48:51], v[160:163]
    s_waitcnt lgkmcnt(1)
    v_lshlrev_b32 v8, 16, v28
    v_lshlrev_b32 v9, 16, v32
    v_mfma_f32_16x16x32_bf16 v[156:159], v[16:19], v[44:47], v[156:159]
    v_and_b32 v10, s36, v28
    v_mfma_f32_16x16x32_bf16 v[152:155], v[16:19], v[40:43], v[152:155]
    v_and_b32 v11, s36, v32
    v_mfma_f32_16x16x32_bf16 v[148:151], v[16:19], v[68:71], v[148:151]
    v_add_f32 v8, v8, v9
    v_add_f32 v10, v10, v11
    v_mfma_f32_16x16x32_bf16 v[144:147], v[16:19], v[64:67], v[144:147]
    v_cvt_pk_bf16_f32 v36, v8, v10
    v_mfma_f32_16x16x32_bf16 v[140:143], v[16:19], v[60:63], v[140:143]
    v_lshlrev_b32 v12, 16, v29
    v_mfma_f32_16x16x32_bf16 v[136:139], v[16:19], v[56:59], v[136:139]
    v_lshlrev_b32 v13, 16, v33
    v_and_b32 v14, s36, v29
    v_mfma_f32_16x16x32_bf16 v[196:199], v[20:23], v[84:87], v[196:199]
    ds_read_b128 v[84:87], v2 offset:13440
    v_mfma_f32_16x16x32_bf16 v[192:195], v[20:23], v[80:83], v[192:195]
    ds_read_b64_tr_b16 v[16:17], v4 offset:49152
    v_and_b32 v15, s36, v33
    v_mfma_f32_16x16x32_bf16 v[188:191], v[20:23], v[76:79], v[188:191]
    ds_read_b64_tr_b16 v[18:19], v4 offset:49664
    v_add_f32 v12, v12, v13
    v_mfma_f32_16x16x32_bf16 v[184:187], v[20:23], v[72:75], v[184:187]
    v_add_f32 v14, v14, v15
    v_mfma_f32_16x16x32_bf16 v[180:183], v[20:23], v[100:103], v[180:183]
    v_cvt_pk_bf16_f32 v37, v12, v14
    v_lshlrev_b32 v8, 16, v30
    v_mfma_f32_16x16x32_bf16 v[176:179], v[20:23], v[96:99], v[176:179]
    v_lshlrev_b32 v9, 16, v34
    v_mfma_f32_16x16x32_bf16 v[172:175], v[20:23], v[92:95], v[172:175]
    v_and_b32 v10, s36, v30
    v_mfma_f32_16x16x32_bf16 v[168:171], v[20:23], v[88:91], v[168:171]
    v_and_b32 v11, s36, v34
    v_add_f32 v8, v8, v9
    v_mfma_f32_16x16x32_bf16 v[228:231], v[24:27], v[116:119], v[228:231]
    ds_read_b128 v[116:119], v2 offset:23168
    v_mfma_f32_16x16x32_bf16 v[224:227], v[24:27], v[112:115], v[224:227]
    ds_read_b64_tr_b16 v[20:21], v4 offset:53248
    v_add_f32 v10, v10, v11
    v_mfma_f32_16x16x32_bf16 v[220:223], v[24:27], v[108:111], v[220:223]
    ds_read_b64_tr_b16 v[22:23], v4 offset:53760
    v_cvt_pk_bf16_f32 v38, v8, v10
    v_mfma_f32_16x16x32_bf16 v[216:219], v[24:27], v[104:107], v[216:219]
    v_lshlrev_b32 v12, 16, v31
    v_mfma_f32_16x16x32_bf16 v[212:215], v[24:27], v[132:135], v[212:215]
    v_lshlrev_b32 v13, 16, v35
    v_mfma_f32_16x16x32_bf16 v[208:211], v[24:27], v[128:131], v[208:211]
    v_and_b32 v14, s36, v31
    v_and_b32 v15, s36, v35
    v_mfma_f32_16x16x32_bf16 v[204:207], v[24:27], v[124:127], v[204:207]
    v_add_f32 v12, v12, v13
    v_mfma_f32_16x16x32_bf16 v[200:203], v[24:27], v[120:123], v[200:203]
    v_add_f32 v14, v14, v15
    v_cvt_pk_bf16_f32 v39, v12, v14
    v_mfma_f32_16x16x32_bf16 v[164:167], v[28:31], v[48:51], v[164:167]
    s_barrier
    ds_read_b128 v[48:51], v2 offset:2496
    v_mfma_f32_16x16x32_bf16 v[160:163], v[28:31], v[44:47], v[160:163]
    s_waitcnt lgkmcnt(1)
    v_lshlrev_b32 v8, 16, v16
    v_lshlrev_b32 v9, 16, v20
    v_mfma_f32_16x16x32_bf16 v[156:159], v[28:31], v[40:43], v[156:159]
    v_and_b32 v10, s36, v16
    v_mfma_f32_16x16x32_bf16 v[152:155], v[28:31], v[68:71], v[152:155]
    v_and_b32 v11, s36, v20
    v_mfma_f32_16x16x32_bf16 v[148:151], v[28:31], v[64:67], v[148:151]
    v_add_f32 v8, v8, v9
    v_add_f32 v10, v10, v11
    v_mfma_f32_16x16x32_bf16 v[144:147], v[28:31], v[60:63], v[144:147]
    v_cvt_pk_bf16_f32 v24, v8, v10
    v_mfma_f32_16x16x32_bf16 v[140:143], v[28:31], v[56:59], v[140:143]
    v_lshlrev_b32 v12, 16, v17
    v_mfma_f32_16x16x32_bf16 v[136:139], v[28:31], v[52:55], v[136:139]
    v_lshlrev_b32 v13, 16, v21
    v_and_b32 v14, s36, v17
    v_mfma_f32_16x16x32_bf16 v[196:199], v[32:35], v[80:83], v[196:199]
    ds_read_b128 v[80:83], v2 offset:12224
    v_mfma_f32_16x16x32_bf16 v[192:195], v[32:35], v[76:79], v[192:195]
    ds_read_b64_tr_b16 v[28:29], v4 offset:57344
    v_and_b32 v15, s36, v21
    v_mfma_f32_16x16x32_bf16 v[188:191], v[32:35], v[72:75], v[188:191]
    ds_read_b64_tr_b16 v[30:31], v4 offset:57856
    v_add_f32 v12, v12, v13
    v_mfma_f32_16x16x32_bf16 v[184:187], v[32:35], v[100:103], v[184:187]
    v_add_f32 v14, v14, v15
    v_mfma_f32_16x16x32_bf16 v[180:183], v[32:35], v[96:99], v[180:183]
    v_cvt_pk_bf16_f32 v25, v12, v14
    v_lshlrev_b32 v8, 16, v18
    v_mfma_f32_16x16x32_bf16 v[176:179], v[32:35], v[92:95], v[176:179]
    v_lshlrev_b32 v9, 16, v22
    v_mfma_f32_16x16x32_bf16 v[172:175], v[32:35], v[88:91], v[172:175]
    v_and_b32 v10, s36, v18
    v_mfma_f32_16x16x32_bf16 v[168:171], v[32:35], v[84:87], v[168:171]
    v_and_b32 v11, s36, v22
    v_add_f32 v8, v8, v9
    v_mfma_f32_16x16x32_bf16 v[228:231], v[36:39], v[112:115], v[228:231]
    ds_read_b128 v[112:115], v2 offset:21952
    v_mfma_f32_16x16x32_bf16 v[224:227], v[36:39], v[108:111], v[224:227]
    ds_read_b64_tr_b16 v[32:33], v4 offset:61440
    v_add_f32 v10, v10, v11
    v_mfma_f32_16x16x32_bf16 v[220:223], v[36:39], v[104:107], v[220:223]
    ds_read_b64_tr_b16 v[34:35], v4 offset:61952
    v_cvt_pk_bf16_f32 v26, v8, v10
    v_mfma_f32_16x16x32_bf16 v[216:219], v[36:39], v[132:135], v[216:219]
    v_lshlrev_b32 v12, 16, v19
    v_mfma_f32_16x16x32_bf16 v[212:215], v[36:39], v[128:131], v[212:215]
    v_lshlrev_b32 v13, 16, v23
    v_mfma_f32_16x16x32_bf16 v[208:211], v[36:39], v[124:127], v[208:211]
    v_and_b32 v14, s36, v19
    v_and_b32 v15, s36, v23
    v_mfma_f32_16x16x32_bf16 v[204:207], v[36:39], v[120:123], v[204:207]
    v_add_f32 v12, v12, v13
    v_mfma_f32_16x16x32_bf16 v[200:203], v[36:39], v[116:119], v[200:203]
    v_add_f32 v14, v14, v15
    v_cvt_pk_bf16_f32 v27, v12, v14
    v_mfma_f32_16x16x32_bf16 v[164:167], v[16:19], v[44:47], v[164:167]
    s_barrier
    ds_read_b128 v[44:47], v2 offset:1280
    v_mfma_f32_16x16x32_bf16 v[160:163], v[16:19], v[40:43], v[160:163]
    s_waitcnt lgkmcnt(1)
    v_lshlrev_b32 v8, 16, v28
    v_lshlrev_b32 v9, 16, v32
    v_mfma_f32_16x16x32_bf16 v[156:159], v[16:19], v[68:71], v[156:159]
    v_and_b32 v10, s36, v28
    v_mfma_f32_16x16x32_bf16 v[152:155], v[16:19], v[64:67], v[152:155]
    v_and_b32 v11, s36, v32
    v_mfma_f32_16x16x32_bf16 v[148:151], v[16:19], v[60:63], v[148:151]
    v_add_f32 v8, v8, v9
    v_add_f32 v10, v10, v11
    v_mfma_f32_16x16x32_bf16 v[144:147], v[16:19], v[56:59], v[144:147]
    v_cvt_pk_bf16_f32 v36, v8, v10
    v_mfma_f32_16x16x32_bf16 v[140:143], v[16:19], v[52:55], v[140:143]
    v_lshlrev_b32 v12, 16, v29
    v_mfma_f32_16x16x32_bf16 v[136:139], v[16:19], v[48:51], v[136:139]
    v_lshlrev_b32 v13, 16, v33
    v_and_b32 v14, s36, v29
    v_mfma_f32_16x16x32_bf16 v[196:199], v[20:23], v[76:79], v[196:199]
    ds_read_b128 v[76:79], v2 offset:11008
    v_mfma_f32_16x16x32_bf16 v[192:195], v[20:23], v[72:75], v[192:195]
    ds_read_b64_tr_b16 v[16:17], v4 offset:0
    v_and_b32 v15, s36, v33
    v_mfma_f32_16x16x32_bf16 v[188:191], v[20:23], v[100:103], v[188:191]
    ds_read_b64_tr_b16 v[18:19], v4 offset:512
    v_add_f32 v12, v12, v13
    v_mfma_f32_16x16x32_bf16 v[184:187], v[20:23], v[96:99], v[184:187]
    v_add_f32 v14, v14, v15
    v_mfma_f32_16x16x32_bf16 v[180:183], v[20:23], v[92:95], v[180:183]
    v_cvt_pk_bf16_f32 v37, v12, v14
    v_lshlrev_b32 v8, 16, v30
    v_mfma_f32_16x16x32_bf16 v[176:179], v[20:23], v[88:91], v[176:179]
    v_lshlrev_b32 v9, 16, v34
    v_mfma_f32_16x16x32_bf16 v[172:175], v[20:23], v[84:87], v[172:175]
    v_and_b32 v10, s36, v30
    v_mfma_f32_16x16x32_bf16 v[168:171], v[20:23], v[80:83], v[168:171]
    v_and_b32 v11, s36, v34
    v_add_f32 v8, v8, v9
    v_mfma_f32_16x16x32_bf16 v[228:231], v[24:27], v[108:111], v[228:231]
    ds_read_b128 v[108:111], v2 offset:20736
    v_mfma_f32_16x16x32_bf16 v[224:227], v[24:27], v[104:107], v[224:227]
    ds_read_b64_tr_b16 v[20:21], v4 offset:4096
    v_add_f32 v10, v10, v11
    v_mfma_f32_16x16x32_bf16 v[220:223], v[24:27], v[132:135], v[220:223]
    ds_read_b64_tr_b16 v[22:23], v4 offset:4608
    v_cvt_pk_bf16_f32 v38, v8, v10
    v_mfma_f32_16x16x32_bf16 v[216:219], v[24:27], v[128:131], v[216:219]
    v_lshlrev_b32 v12, 16, v31
    v_mfma_f32_16x16x32_bf16 v[212:215], v[24:27], v[124:127], v[212:215]
    v_lshlrev_b32 v13, 16, v35
    v_mfma_f32_16x16x32_bf16 v[208:211], v[24:27], v[120:123], v[208:211]
    v_and_b32 v14, s36, v31
    v_and_b32 v15, s36, v35
    v_mfma_f32_16x16x32_bf16 v[204:207], v[24:27], v[116:119], v[204:207]
    v_add_f32 v12, v12, v13
    v_mfma_f32_16x16x32_bf16 v[200:203], v[24:27], v[112:115], v[200:203]
    v_add_f32 v14, v14, v15
    v_cvt_pk_bf16_f32 v39, v12, v14
    v_mfma_f32_16x16x32_bf16 v[164:167], v[28:31], v[40:43], v[164:167]
    s_barrier
    ds_read_b128 v[40:43], v2 offset:64
    v_mfma_f32_16x16x32_bf16 v[160:163], v[28:31], v[68:71], v[160:163]
    s_waitcnt lgkmcnt(1)
    v_lshlrev_b32 v8, 16, v16
    v_lshlrev_b32 v9, 16, v20
    v_mfma_f32_16x16x32_bf16 v[156:159], v[28:31], v[64:67], v[156:159]
    v_and_b32 v10, s36, v16
    v_mfma_f32_16x16x32_bf16 v[152:155], v[28:31], v[60:63], v[152:155]
    v_and_b32 v11, s36, v20
    v_mfma_f32_16x16x32_bf16 v[148:151], v[28:31], v[56:59], v[148:151]
    v_add_f32 v8, v8, v9
    v_add_f32 v10, v10, v11
    v_mfma_f32_16x16x32_bf16 v[144:147], v[28:31], v[52:55], v[144:147]
    v_cvt_pk_bf16_f32 v24, v8, v10
    v_mfma_f32_16x16x32_bf16 v[140:143], v[28:31], v[48:51], v[140:143]
    v_lshlrev_b32 v12, 16, v17
    v_mfma_f32_16x16x32_bf16 v[136:139], v[28:31], v[44:47], v[136:139]
    v_lshlrev_b32 v13, 16, v21
    v_and_b32 v14, s36, v17
    v_mfma_f32_16x16x32_bf16 v[196:199], v[32:35], v[72:75], v[196:199]
    ds_read_b128 v[72:75], v2 offset:9792
    v_mfma_f32_16x16x32_bf16 v[192:195], v[32:35], v[100:103], v[192:195]
    ds_read_b64_tr_b16 v[28:29], v4 offset:8192
    v_and_b32 v15, s36, v21
    v_mfma_f32_16x16x32_bf16 v[188:191], v[32:35], v[96:99], v[188:191]
    ds_read_b64_tr_b16 v[30:31], v4 offset:8704
    v_add_f32 v12, v12, v13
    v_mfma_f32_16x16x32_bf16 v[184:187], v[32:35], v[92:95], v[184:187]
    v_add_f32 v14, v14, v15
    v_mfma_f32_16x16x32_bf16 v[180:183], v[32:35], v[88:91], v[180:183]
    v_cvt_pk_bf16_f32 v25, v12, v14
    v_lshlrev_b32 v8, 16, v18
    v_mfma_f32_16x16x32_bf16 v[176:179], v[32:35], v[84:87], v[176:179]
    v_lshlrev_b32 v9, 16, v22
    v_mfma_f32_16x16x32_bf16 v[172:175], v[32:35], v[80:83], v[172:175]
    v_and_b32 v10, s36, v18
    v_mfma_f32_16x16x32_bf16 v[168:171], v[32:35], v[76:79], v[168:171]
    v_and_b32 v11, s36, v22
    v_add_f32 v8, v8, v9
    v_mfma_f32_16x16x32_bf16 v[228:231], v[36:39], v[104:107], v[228:231]
    ds_read_b128 v[104:107], v2 offset:19520
    v_mfma_f32_16x16x32_bf16 v[224:227], v[36:39], v[132:135], v[224:227]
    ds_read_b64_tr_b16 v[32:33], v4 offset:12288
    v_add_f32 v10, v10, v11
    v_mfma_f32_16x16x32_bf16 v[220:223], v[36:39], v[128:131], v[220:223]
    ds_read_b64_tr_b16 v[34:35], v4 offset:12800
    v_cvt_pk_bf16_f32 v26, v8, v10
    v_mfma_f32_16x16x32_bf16 v[216:219], v[36:39], v[124:127], v[216:219]
    v_lshlrev_b32 v12, 16, v19
    v_mfma_f32_16x16x32_bf16 v[212:215], v[36:39], v[120:123], v[212:215]
    v_lshlrev_b32 v13, 16, v23
    v_mfma_f32_16x16x32_bf16 v[208:211], v[36:39], v[116:119], v[208:211]
    v_and_b32 v14, s36, v19
    v_and_b32 v15, s36, v23
    v_mfma_f32_16x16x32_bf16 v[204:207], v[36:39], v[112:115], v[204:207]
    v_add_f32 v12, v12, v13
    v_mfma_f32_16x16x32_bf16 v[200:203], v[36:39], v[108:111], v[200:203]
    v_add_f32 v14, v14, v15
    v_cvt_pk_bf16_f32 v27, v12, v14
    v_mfma_f32_16x16x32_bf16 v[164:167], v[16:19], v[68:71], v[164:167]
    s_barrier
    ds_read_b128 v[68:71], v1 offset:8512
    v_mfma_f32_16x16x32_bf16 v[160:163], v[16:19], v[64:67], v[160:163]
    s_waitcnt lgkmcnt(1)
    v_lshlrev_b32 v8, 16, v28
    v_lshlrev_b32 v9, 16, v32
    v_mfma_f32_16x16x32_bf16 v[156:159], v[16:19], v[60:63], v[156:159]
    v_and_b32 v10, s36, v28
    v_mfma_f32_16x16x32_bf16 v[152:155], v[16:19], v[56:59], v[152:155]
    v_and_b32 v11, s36, v32
    v_mfma_f32_16x16x32_bf16 v[148:151], v[16:19], v[52:55], v[148:151]
    v_add_f32 v8, v8, v9
    v_add_f32 v10, v10, v11
    v_mfma_f32_16x16x32_bf16 v[144:147], v[16:19], v[48:51], v[144:147]
    v_cvt_pk_bf16_f32 v36, v8, v10
    v_mfma_f32_16x16x32_bf16 v[140:143], v[16:19], v[44:47], v[140:143]
    v_lshlrev_b32 v12, 16, v29
    v_mfma_f32_16x16x32_bf16 v[136:139], v[16:19], v[40:43], v[136:139]
    v_lshlrev_b32 v13, 16, v33
    v_and_b32 v14, s36, v29
    v_mfma_f32_16x16x32_bf16 v[196:199], v[20:23], v[100:103], v[196:199]
    ds_read_b128 v[100:103], v1 offset:18240
    v_mfma_f32_16x16x32_bf16 v[192:195], v[20:23], v[96:99], v[192:195]
    ds_read_b64_tr_b16 v[16:17], v4 offset:16384
    v_and_b32 v15, s36, v33
    v_mfma_f32_16x16x32_bf16 v[188:191], v[20:23], v[92:95], v[188:191]
    ds_read_b64_tr_b16 v[18:19], v4 offset:16896
    v_add_f32 v12, v12, v13
    v_mfma_f32_16x16x32_bf16 v[184:187], v[20:23], v[88:91], v[184:187]
    v_add_f32 v14, v14, v15
    v_mfma_f32_16x16x32_bf16 v[180:183], v[20:23], v[84:87], v[180:183]
    v_cvt_pk_bf16_f32 v37, v12, v14
    v_lshlrev_b32 v8, 16, v30
    v_mfma_f32_16x16x32_bf16 v[176:179], v[20:23], v[80:83], v[176:179]
    v_lshlrev_b32 v9, 16, v34
    v_mfma_f32_16x16x32_bf16 v[172:175], v[20:23], v[76:79], v[172:175]
    v_and_b32 v10, s36, v30
    v_mfma_f32_16x16x32_bf16 v[168:171], v[20:23], v[72:75], v[168:171]
    v_and_b32 v11, s36, v34
    v_add_f32 v8, v8, v9
    v_mfma_f32_16x16x32_bf16 v[228:231], v[24:27], v[132:135], v[228:231]
    ds_read_b128 v[132:135], v1 offset:27968
    v_mfma_f32_16x16x32_bf16 v[224:227], v[24:27], v[128:131], v[224:227]
    ds_read_b64_tr_b16 v[20:21], v4 offset:20480
    v_add_f32 v10, v10, v11
    v_mfma_f32_16x16x32_bf16 v[220:223], v[24:27], v[124:127], v[220:223]
    ds_read_b64_tr_b16 v[22:23], v4 offset:20992
    v_cvt_pk_bf16_f32 v38, v8, v10
    v_mfma_f32_16x16x32_bf16 v[216:219], v[24:27], v[120:123], v[216:219]
    v_lshlrev_b32 v12, 16, v31
    v_mfma_f32_16x16x32_bf16 v[212:215], v[24:27], v[116:119], v[212:215]
    v_lshlrev_b32 v13, 16, v35
    v_mfma_f32_16x16x32_bf16 v[208:211], v[24:27], v[112:115], v[208:211]
    v_and_b32 v14, s36, v31
    v_and_b32 v15, s36, v35
    v_mfma_f32_16x16x32_bf16 v[204:207], v[24:27], v[108:111], v[204:207]
    v_add_f32 v12, v12, v13
    v_mfma_f32_16x16x32_bf16 v[200:203], v[24:27], v[104:107], v[200:203]
    v_add_f32 v14, v14, v15
    v_cvt_pk_bf16_f32 v39, v12, v14
    v_mfma_f32_16x16x32_bf16 v[164:167], v[28:31], v[64:67], v[164:167]
    s_barrier
    ds_read_b128 v[64:67], v1 offset:7296
    v_mfma_f32_16x16x32_bf16 v[160:163], v[28:31], v[60:63], v[160:163]
    s_waitcnt lgkmcnt(1)
    v_lshlrev_b32 v8, 16, v16
    v_lshlrev_b32 v9, 16, v20
    v_mfma_f32_16x16x32_bf16 v[156:159], v[28:31], v[56:59], v[156:159]
    v_and_b32 v10, s36, v16
    v_mfma_f32_16x16x32_bf16 v[152:155], v[28:31], v[52:55], v[152:155]
    v_and_b32 v11, s36, v20
    v_mfma_f32_16x16x32_bf16 v[148:151], v[28:31], v[48:51], v[148:151]
    v_add_f32 v8, v8, v9
    v_add_f32 v10, v10, v11
    v_mfma_f32_16x16x32_bf16 v[144:147], v[28:31], v[44:47], v[144:147]
    v_cvt_pk_bf16_f32 v24, v8, v10
    v_mfma_f32_16x16x32_bf16 v[140:143], v[28:31], v[40:43], v[140:143]
    v_lshlrev_b32 v12, 16, v17
    v_mfma_f32_16x16x32_bf16 v[136:139], v[28:31], v[68:71], v[136:139]
    v_lshlrev_b32 v13, 16, v21
    v_and_b32 v14, s36, v17
    v_mfma_f32_16x16x32_bf16 v[196:199], v[32:35], v[96:99], v[196:199]
    ds_read_b128 v[96:99], v1 offset:17024
    v_mfma_f32_16x16x32_bf16 v[192:195], v[32:35], v[92:95], v[192:195]
    ds_read_b64_tr_b16 v[28:29], v4 offset:24576
    v_and_b32 v15, s36, v21
    v_mfma_f32_16x16x32_bf16 v[188:191], v[32:35], v[88:91], v[188:191]
    ds_read_b64_tr_b16 v[30:31], v4 offset:25088
    v_add_f32 v12, v12, v13
    v_mfma_f32_16x16x32_bf16 v[184:187], v[32:35], v[84:87], v[184:187]
    v_add_f32 v14, v14, v15
    v_mfma_f32_16x16x32_bf16 v[180:183], v[32:35], v[80:83], v[180:183]
    v_cvt_pk_bf16_f32 v25, v12, v14
    v_lshlrev_b32 v8, 16, v18
    v_mfma_f32_16x16x32_bf16 v[176:179], v[32:35], v[76:79], v[176:179]
    v_lshlrev_b32 v9, 16, v22
    v_mfma_f32_16x16x32_bf16 v[172:175], v[32:35], v[72:75], v[172:175]
    v_and_b32 v10, s36, v18
    v_mfma_f32_16x16x32_bf16 v[168:171], v[32:35], v[100:103], v[168:171]
    v_and_b32 v11, s36, v22
    v_add_f32 v8, v8, v9
    v_mfma_f32_16x16x32_bf16 v[228:231], v[36:39], v[128:131], v[228:231]
    ds_read_b128 v[128:131], v1 offset:26752
    v_mfma_f32_16x16x32_bf16 v[224:227], v[36:39], v[124:127], v[224:227]
    ds_read_b64_tr_b16 v[32:33], v4 offset:28672
    v_add_f32 v10, v10, v11
    v_mfma_f32_16x16x32_bf16 v[220:223], v[36:39], v[120:123], v[220:223]
    ds_read_b64_tr_b16 v[34:35], v4 offset:29184
    v_cvt_pk_bf16_f32 v26, v8, v10
    v_mfma_f32_16x16x32_bf16 v[216:219], v[36:39], v[116:119], v[216:219]
    v_lshlrev_b32 v12, 16, v19
    v_mfma_f32_16x16x32_bf16 v[212:215], v[36:39], v[112:115], v[212:215]
    v_lshlrev_b32 v13, 16, v23
    v_mfma_f32_16x16x32_bf16 v[208:211], v[36:39], v[108:111], v[208:211]
    v_and_b32 v14, s36, v19
    v_and_b32 v15, s36, v23
    v_mfma_f32_16x16x32_bf16 v[204:207], v[36:39], v[104:107], v[204:207]
    v_add_f32 v12, v12, v13
    v_mfma_f32_16x16x32_bf16 v[200:203], v[36:39], v[132:135], v[200:203]
    v_add_f32 v14, v14, v15
    v_cvt_pk_bf16_f32 v27, v12, v14
    v_mfma_f32_16x16x32_bf16 v[164:167], v[16:19], v[60:63], v[164:167]
    s_barrier
    ds_read_b128 v[60:63], v1 offset:6080
    v_mfma_f32_16x16x32_bf16 v[160:163], v[16:19], v[56:59], v[160:163]
    s_waitcnt lgkmcnt(1)
    v_lshlrev_b32 v8, 16, v28
    v_lshlrev_b32 v9, 16, v32
    v_mfma_f32_16x16x32_bf16 v[156:159], v[16:19], v[52:55], v[156:159]
    v_and_b32 v10, s36, v28
    v_mfma_f32_16x16x32_bf16 v[152:155], v[16:19], v[48:51], v[152:155]
    v_and_b32 v11, s36, v32
    v_mfma_f32_16x16x32_bf16 v[148:151], v[16:19], v[44:47], v[148:151]
    v_add_f32 v8, v8, v9
    v_add_f32 v10, v10, v11
    v_mfma_f32_16x16x32_bf16 v[144:147], v[16:19], v[40:43], v[144:147]
    v_cvt_pk_bf16_f32 v36, v8, v10
    v_mfma_f32_16x16x32_bf16 v[140:143], v[16:19], v[68:71], v[140:143]
    v_lshlrev_b32 v12, 16, v29
    v_mfma_f32_16x16x32_bf16 v[136:139], v[16:19], v[64:67], v[136:139]
    v_lshlrev_b32 v13, 16, v33
    v_and_b32 v14, s36, v29
    v_mfma_f32_16x16x32_bf16 v[196:199], v[20:23], v[92:95], v[196:199]
    ds_read_b128 v[92:95], v1 offset:15808
    v_mfma_f32_16x16x32_bf16 v[192:195], v[20:23], v[88:91], v[192:195]
    ds_read_b64_tr_b16 v[16:17], v4 offset:32768
    v_and_b32 v15, s36, v33
    v_mfma_f32_16x16x32_bf16 v[188:191], v[20:23], v[84:87], v[188:191]
    ds_read_b64_tr_b16 v[18:19], v4 offset:33280
    v_add_f32 v12, v12, v13
    v_mfma_f32_16x16x32_bf16 v[184:187], v[20:23], v[80:83], v[184:187]
    v_add_f32 v14, v14, v15
    v_mfma_f32_16x16x32_bf16 v[180:183], v[20:23], v[76:79], v[180:183]
    v_cvt_pk_bf16_f32 v37, v12, v14
    v_lshlrev_b32 v8, 16, v30
    v_mfma_f32_16x16x32_bf16 v[176:179], v[20:23], v[72:75], v[176:179]
    v_lshlrev_b32 v9, 16, v34
    v_mfma_f32_16x16x32_bf16 v[172:175], v[20:23], v[100:103], v[172:175]
    v_and_b32 v10, s36, v30
    v_mfma_f32_16x16x32_bf16 v[168:171], v[20:23], v[96:99], v[168:171]
    v_and_b32 v11, s36, v34
    v_add_f32 v8, v8, v9
    v_mfma_f32_16x16x32_bf16 v[228:231], v[24:27], v[124:127], v[228:231]
    ds_read_b128 v[124:127], v1 offset:25536
    v_mfma_f32_16x16x32_bf16 v[224:227], v[24:27], v[120:123], v[224:227]
    ds_read_b64_tr_b16 v[20:21], v4 offset:36864
    v_add_f32 v10, v10, v11
    v_mfma_f32_16x16x32_bf16 v[220:223], v[24:27], v[116:119], v[220:223]
    ds_read_b64_tr_b16 v[22:23], v4 offset:37376
    v_cvt_pk_bf16_f32 v38, v8, v10
    v_mfma_f32_16x16x32_bf16 v[216:219], v[24:27], v[112:115], v[216:219]
    v_lshlrev_b32 v12, 16, v31
    v_mfma_f32_16x16x32_bf16 v[212:215], v[24:27], v[108:111], v[212:215]
    v_lshlrev_b32 v13, 16, v35
    v_mfma_f32_16x16x32_bf16 v[208:211], v[24:27], v[104:107], v[208:211]
    v_and_b32 v14, s36, v31
    v_and_b32 v15, s36, v35
    v_mfma_f32_16x16x32_bf16 v[204:207], v[24:27], v[132:135], v[204:207]
    v_add_f32 v12, v12, v13
    v_mfma_f32_16x16x32_bf16 v[200:203], v[24:27], v[128:131], v[200:203]
    v_add_f32 v14, v14, v15
    v_cvt_pk_bf16_f32 v39, v12, v14
    v_mfma_f32_16x16x32_bf16 v[164:167], v[28:31], v[56:59], v[164:167]
    s_barrier
    ds_read_b128 v[56:59], v1 offset:4864
    v_mfma_f32_16x16x32_bf16 v[160:163], v[28:31], v[52:55], v[160:163]
    s_waitcnt lgkmcnt(1)
    v_lshlrev_b32 v8, 16, v16
    v_lshlrev_b32 v9, 16, v20
    v_mfma_f32_16x16x32_bf16 v[156:159], v[28:31], v[48:51], v[156:159]
    v_and_b32 v10, s36, v16
    v_mfma_f32_16x16x32_bf16 v[152:155], v[28:31], v[44:47], v[152:155]
    v_and_b32 v11, s36, v20
    v_mfma_f32_16x16x32_bf16 v[148:151], v[28:31], v[40:43], v[148:151]
    v_add_f32 v8, v8, v9
    v_add_f32 v10, v10, v11
    v_mfma_f32_16x16x32_bf16 v[144:147], v[28:31], v[68:71], v[144:147]
    v_cvt_pk_bf16_f32 v24, v8, v10
    v_mfma_f32_16x16x32_bf16 v[140:143], v[28:31], v[64:67], v[140:143]
    v_lshlrev_b32 v12, 16, v17
    v_mfma_f32_16x16x32_bf16 v[136:139], v[28:31], v[60:63], v[136:139]
    v_lshlrev_b32 v13, 16, v21
    v_and_b32 v14, s36, v17
    v_mfma_f32_16x16x32_bf16 v[196:199], v[32:35], v[88:91], v[196:199]
    ds_read_b128 v[88:91], v1 offset:14592
    v_mfma_f32_16x16x32_bf16 v[192:195], v[32:35], v[84:87], v[192:195]
    ds_read_b64_tr_b16 v[28:29], v4 offset:40960
    v_and_b32 v15, s36, v21
    v_mfma_f32_16x16x32_bf16 v[188:191], v[32:35], v[80:83], v[188:191]
    ds_read_b64_tr_b16 v[30:31], v4 offset:41472
    v_add_f32 v12, v12, v13
    v_mfma_f32_16x16x32_bf16 v[184:187], v[32:35], v[76:79], v[184:187]
    v_add_f32 v14, v14, v15
    v_mfma_f32_16x16x32_bf16 v[180:183], v[32:35], v[72:75], v[180:183]
    v_cvt_pk_bf16_f32 v25, v12, v14
    v_lshlrev_b32 v8, 16, v18
    v_mfma_f32_16x16x32_bf16 v[176:179], v[32:35], v[100:103], v[176:179]
    v_lshlrev_b32 v9, 16, v22
    v_mfma_f32_16x16x32_bf16 v[172:175], v[32:35], v[96:99], v[172:175]
    v_and_b32 v10, s36, v18
    v_mfma_f32_16x16x32_bf16 v[168:171], v[32:35], v[92:95], v[168:171]
    v_and_b32 v11, s36, v22
    v_add_f32 v8, v8, v9
    v_mfma_f32_16x16x32_bf16 v[228:231], v[36:39], v[120:123], v[228:231]
    ds_read_b128 v[120:123], v1 offset:24320
    v_mfma_f32_16x16x32_bf16 v[224:227], v[36:39], v[116:119], v[224:227]
    ds_read_b64_tr_b16 v[32:33], v4 offset:45056
    v_add_f32 v10, v10, v11
    v_mfma_f32_16x16x32_bf16 v[220:223], v[36:39], v[112:115], v[220:223]
    ds_read_b64_tr_b16 v[34:35], v4 offset:45568
    v_cvt_pk_bf16_f32 v26, v8, v10
    v_mfma_f32_16x16x32_bf16 v[216:219], v[36:39], v[108:111], v[216:219]
    v_lshlrev_b32 v12, 16, v19
    v_mfma_f32_16x16x32_bf16 v[212:215], v[36:39], v[104:107], v[212:215]
    v_lshlrev_b32 v13, 16, v23
    v_mfma_f32_16x16x32_bf16 v[208:211], v[36:39], v[132:135], v[208:211]
    v_and_b32 v14, s36, v19
    v_and_b32 v15, s36, v23
    v_mfma_f32_16x16x32_bf16 v[204:207], v[36:39], v[128:131], v[204:207]
    v_add_f32 v12, v12, v13
    v_mfma_f32_16x16x32_bf16 v[200:203], v[36:39], v[124:127], v[200:203]
    v_add_f32 v14, v14, v15
    v_cvt_pk_bf16_f32 v27, v12, v14
    v_mfma_f32_16x16x32_bf16 v[164:167], v[16:19], v[52:55], v[164:167]
    s_barrier
    ds_read_b128 v[52:55], v1 offset:3648
    v_mfma_f32_16x16x32_bf16 v[160:163], v[16:19], v[48:51], v[160:163]
    s_waitcnt lgkmcnt(1)
    v_lshlrev_b32 v8, 16, v28
    v_lshlrev_b32 v9, 16, v32
    v_mfma_f32_16x16x32_bf16 v[156:159], v[16:19], v[44:47], v[156:159]
    v_and_b32 v10, s36, v28
    v_mfma_f32_16x16x32_bf16 v[152:155], v[16:19], v[40:43], v[152:155]
    v_and_b32 v11, s36, v32
    v_mfma_f32_16x16x32_bf16 v[148:151], v[16:19], v[68:71], v[148:151]
    v_add_f32 v8, v8, v9
    v_add_f32 v10, v10, v11
    v_mfma_f32_16x16x32_bf16 v[144:147], v[16:19], v[64:67], v[144:147]
    v_cvt_pk_bf16_f32 v36, v8, v10
    v_mfma_f32_16x16x32_bf16 v[140:143], v[16:19], v[60:63], v[140:143]
    v_lshlrev_b32 v12, 16, v29
    v_mfma_f32_16x16x32_bf16 v[136:139], v[16:19], v[56:59], v[136:139]
    v_lshlrev_b32 v13, 16, v33
    v_and_b32 v14, s36, v29
    v_mfma_f32_16x16x32_bf16 v[196:199], v[20:23], v[84:87], v[196:199]
    ds_read_b128 v[84:87], v1 offset:13376
    v_mfma_f32_16x16x32_bf16 v[192:195], v[20:23], v[80:83], v[192:195]
    ds_read_b64_tr_b16 v[16:17], v4 offset:49152
    v_and_b32 v15, s36, v33
    v_mfma_f32_16x16x32_bf16 v[188:191], v[20:23], v[76:79], v[188:191]
    ds_read_b64_tr_b16 v[18:19], v4 offset:49664
    v_add_f32 v12, v12, v13
    v_mfma_f32_16x16x32_bf16 v[184:187], v[20:23], v[72:75], v[184:187]
    v_add_f32 v14, v14, v15
    v_mfma_f32_16x16x32_bf16 v[180:183], v[20:23], v[100:103], v[180:183]
    v_cvt_pk_bf16_f32 v37, v12, v14
    v_lshlrev_b32 v8, 16, v30
    v_mfma_f32_16x16x32_bf16 v[176:179], v[20:23], v[96:99], v[176:179]
    v_lshlrev_b32 v9, 16, v34
    v_mfma_f32_16x16x32_bf16 v[172:175], v[20:23], v[92:95], v[172:175]
    v_and_b32 v10, s36, v30
    v_mfma_f32_16x16x32_bf16 v[168:171], v[20:23], v[88:91], v[168:171]
    v_and_b32 v11, s36, v34
    v_add_f32 v8, v8, v9
    v_mfma_f32_16x16x32_bf16 v[228:231], v[24:27], v[116:119], v[228:231]
    ds_read_b128 v[116:119], v1 offset:23104
    v_mfma_f32_16x16x32_bf16 v[224:227], v[24:27], v[112:115], v[224:227]
    ds_read_b64_tr_b16 v[20:21], v4 offset:53248
    v_add_f32 v10, v10, v11
    v_mfma_f32_16x16x32_bf16 v[220:223], v[24:27], v[108:111], v[220:223]
    ds_read_b64_tr_b16 v[22:23], v4 offset:53760
    v_cvt_pk_bf16_f32 v38, v8, v10
    v_mfma_f32_16x16x32_bf16 v[216:219], v[24:27], v[104:107], v[216:219]
    v_lshlrev_b32 v12, 16, v31
    v_mfma_f32_16x16x32_bf16 v[212:215], v[24:27], v[132:135], v[212:215]
    v_lshlrev_b32 v13, 16, v35
    v_mfma_f32_16x16x32_bf16 v[208:211], v[24:27], v[128:131], v[208:211]
    v_and_b32 v14, s36, v31
    v_and_b32 v15, s36, v35
    v_mfma_f32_16x16x32_bf16 v[204:207], v[24:27], v[124:127], v[204:207]
    v_add_f32 v12, v12, v13
    v_mfma_f32_16x16x32_bf16 v[200:203], v[24:27], v[120:123], v[200:203]
    v_add_f32 v14, v14, v15
    v_cvt_pk_bf16_f32 v39, v12, v14
    v_mfma_f32_16x16x32_bf16 v[164:167], v[28:31], v[48:51], v[164:167]
    s_barrier
    ds_read_b128 v[48:51], v1 offset:2432
    v_mfma_f32_16x16x32_bf16 v[160:163], v[28:31], v[44:47], v[160:163]
    s_waitcnt lgkmcnt(1)
    v_lshlrev_b32 v8, 16, v16
    v_mfma_f32_16x16x32_bf16 v[156:159], v[28:31], v[40:43], v[156:159]
    v_lshlrev_b32 v9, 16, v20
    v_and_b32 v10, s36, v16
    v_mfma_f32_16x16x32_bf16 v[152:155], v[28:31], v[68:71], v[152:155]
    v_and_b32 v11, s36, v20
    v_mfma_f32_16x16x32_bf16 v[148:151], v[28:31], v[64:67], v[148:151]
    v_add_f32 v8, v8, v9
    v_mfma_f32_16x16x32_bf16 v[144:147], v[28:31], v[60:63], v[144:147]
    v_add_f32 v10, v10, v11
    v_mfma_f32_16x16x32_bf16 v[140:143], v[28:31], v[56:59], v[140:143]
    v_cvt_pk_bf16_f32 v24, v8, v10
    v_lshlrev_b32 v12, 16, v17
    v_mfma_f32_16x16x32_bf16 v[136:139], v[28:31], v[52:55], v[136:139]
    v_lshlrev_b32 v13, 16, v21
    v_mfma_f32_16x16x32_bf16 v[196:199], v[32:35], v[80:83], v[196:199]
    ds_read_b128 v[80:83], v1 offset:12160
    v_mfma_f32_16x16x32_bf16 v[192:195], v[32:35], v[76:79], v[192:195]
    v_and_b32 v14, s36, v17
    v_and_b32 v15, s36, v21
    v_mfma_f32_16x16x32_bf16 v[188:191], v[32:35], v[72:75], v[188:191]
    v_add_f32 v12, v12, v13
    v_mfma_f32_16x16x32_bf16 v[184:187], v[32:35], v[100:103], v[184:187]
    v_add_f32 v14, v14, v15
    v_mfma_f32_16x16x32_bf16 v[180:183], v[32:35], v[96:99], v[180:183]
    v_cvt_pk_bf16_f32 v25, v12, v14
    v_mfma_f32_16x16x32_bf16 v[176:179], v[32:35], v[92:95], v[176:179]
    v_lshlrev_b32 v8, 16, v18
    v_lshlrev_b32 v9, 16, v22
    v_mfma_f32_16x16x32_bf16 v[172:175], v[32:35], v[88:91], v[172:175]
    v_and_b32 v10, s36, v18
    v_mfma_f32_16x16x32_bf16 v[168:171], v[32:35], v[84:87], v[168:171]
    v_and_b32 v11, s36, v22
    v_mfma_f32_16x16x32_bf16 v[228:231], v[36:39], v[112:115], v[228:231]
    ds_read_b128 v[112:115], v1 offset:21888
    v_add_f32 v8, v8, v9
    v_mfma_f32_16x16x32_bf16 v[224:227], v[36:39], v[108:111], v[224:227]
    v_add_f32 v10, v10, v11
    v_mfma_f32_16x16x32_bf16 v[220:223], v[36:39], v[104:107], v[220:223]
    v_cvt_pk_bf16_f32 v26, v8, v10
    v_mfma_f32_16x16x32_bf16 v[216:219], v[36:39], v[132:135], v[216:219]
    v_lshlrev_b32 v12, 16, v19
    v_lshlrev_b32 v13, 16, v23
    v_mfma_f32_16x16x32_bf16 v[212:215], v[36:39], v[128:131], v[212:215]
    v_and_b32 v14, s36, v19
    v_mfma_f32_16x16x32_bf16 v[208:211], v[36:39], v[124:127], v[208:211]
    v_and_b32 v15, s36, v23
    v_mfma_f32_16x16x32_bf16 v[204:207], v[36:39], v[120:123], v[204:207]
    v_add_f32 v12, v12, v13
    v_mfma_f32_16x16x32_bf16 v[200:203], v[36:39], v[116:119], v[200:203]
    v_add_f32 v14, v14, v15
    v_cvt_pk_bf16_f32 v27, v12, v14
    v_mfma_f32_16x16x32_bf16 v[164:167], v[16:19], v[44:47], v[164:167]
    s_barrier
    ds_read_b128 v[44:47], v3 offset:1344
    ds_read_b64_tr_b16 v[232:233], v4 offset:0
    v_mfma_f32_16x16x32_bf16 v[160:163], v[16:19], v[40:43], v[160:163]
    ds_read_b128 v[40:43], v3 offset:128
    ds_read_b64_tr_b16 v[234:235], v4 offset:512
    v_mfma_f32_16x16x32_bf16 v[156:159], v[16:19], v[68:71], v[156:159]
    ds_read_b128 v[68:71], v3 offset:8640
    ds_read_b64_tr_b16 v[236:237], v4 offset:4096
    v_mfma_f32_16x16x32_bf16 v[152:155], v[16:19], v[64:67], v[152:155]
    ds_read_b128 v[64:67], v3 offset:7424
    ds_read_b64_tr_b16 v[238:239], v4 offset:4608
    v_mfma_f32_16x16x32_bf16 v[148:151], v[16:19], v[60:63], v[148:151]
    ds_read_b128 v[60:63], v3 offset:6208
    ds_read_b64_tr_b16 v[36:37], v4 offset:61440
    v_mfma_f32_16x16x32_bf16 v[144:147], v[16:19], v[56:59], v[144:147]
    ds_read_b128 v[56:59], v3 offset:4992
    ds_read_b64_tr_b16 v[38:39], v4 offset:61952
    v_mfma_f32_16x16x32_bf16 v[140:143], v[16:19], v[52:55], v[140:143]
    ds_read_b128 v[52:55], v3 offset:3776
    s_waitcnt lgkmcnt(15)
    v_mfma_f32_16x16x32_bf16 v[136:139], v[16:19], v[48:51], v[136:139]
    ds_read_b128 v[48:51], v3 offset:2560
    v_mfma_f32_16x16x32_bf16 v[196:199], v[20:23], v[76:79], v[196:199]
    ds_read_b128 v[76:79], v1 offset:10944
    v_mfma_f32_16x16x32_bf16 v[192:195], v[20:23], v[72:75], v[192:195]
    s_waitcnt lgkmcnt(7)
    v_lshlrev_b32 v8, 16, v232
    v_mfma_f32_16x16x32_bf16 v[188:191], v[20:23], v[100:103], v[188:191]
    v_lshlrev_b32 v9, 16, v236
    v_and_b32 v10, s36, v232
    v_mfma_f32_16x16x32_bf16 v[184:187], v[20:23], v[96:99], v[184:187]
    v_and_b32 v11, s36, v236
    v_add_f32 v8, v8, v9
    v_mfma_f32_16x16x32_bf16 v[180:183], v[20:23], v[92:95], v[180:183]
    v_add_f32 v10, v10, v11
    v_cvt_pk_bf16_f32 v240, v8, v10
    v_mfma_f32_16x16x32_bf16 v[176:179], v[20:23], v[88:91], v[176:179]
    v_lshlrev_b32 v12, 16, v233
    v_lshlrev_b32 v13, 16, v237
    v_mfma_f32_16x16x32_bf16 v[172:175], v[20:23], v[84:87], v[172:175]
    v_and_b32 v14, s36, v233
    v_and_b32 v15, s36, v237
    v_mfma_f32_16x16x32_bf16 v[168:171], v[20:23], v[80:83], v[168:171]
    v_add_f32 v12, v12, v13
    v_add_f32 v14, v14, v15
    v_mfma_f32_16x16x32_bf16 v[228:231], v[24:27], v[108:111], v[228:231]
    ds_read_b128 v[108:111], v1 offset:20672
    v_cvt_pk_bf16_f32 v241, v12, v14
    v_mfma_f32_16x16x32_bf16 v[224:227], v[24:27], v[104:107], v[224:227]
    v_lshlrev_b32 v8, 16, v234
    v_lshlrev_b32 v9, 16, v238
    v_mfma_f32_16x16x32_bf16 v[220:223], v[24:27], v[132:135], v[220:223]
    v_and_b32 v10, s36, v234
    v_and_b32 v11, s36, v238
    v_mfma_f32_16x16x32_bf16 v[216:219], v[24:27], v[128:131], v[216:219]
    v_add_f32 v8, v8, v9
    v_add_f32 v10, v10, v11
    v_mfma_f32_16x16x32_bf16 v[212:215], v[24:27], v[124:127], v[212:215]
    v_cvt_pk_bf16_f32 v242, v8, v10
    v_lshlrev_b32 v12, 16, v235
    v_mfma_f32_16x16x32_bf16 v[208:211], v[24:27], v[120:123], v[208:211]
    v_lshlrev_b32 v13, 16, v239
    v_and_b32 v14, s36, v235
    v_mfma_f32_16x16x32_bf16 v[204:207], v[24:27], v[116:119], v[204:207]
    v_and_b32 v15, s36, v239
    v_add_f32 v12, v12, v13
    v_mfma_f32_16x16x32_bf16 v[200:203], v[24:27], v[112:115], v[200:203]
    v_add_f32 v14, v14, v15
    v_cvt_pk_bf16_f32 v243, v12, v14
    s_waitcnt lgkmcnt(0)
    v_mfma_f32_16x16x32_bf16 v[196:199], v[36:39], v[72:75], v[196:199]
    s_barrier
    ds_read_b128 v[72:75], v3 offset:9856
    v_mfma_f32_16x16x32_bf16 v[192:195], v[36:39], v[100:103], v[192:195]
    ds_read_b128 v[100:103], v3 offset:18368
    ds_read_b64_tr_b16 v[28:29], v4 offset:8192
    v_mfma_f32_16x16x32_bf16 v[188:191], v[36:39], v[96:99], v[188:191]
    ds_read_b128 v[96:99], v3 offset:17152
    v_mfma_f32_16x16x32_bf16 v[184:187], v[36:39], v[92:95], v[184:187]
    ds_read_b128 v[92:95], v3 offset:15936
    ds_read_b64_tr_b16 v[30:31], v4 offset:8704
    v_mfma_f32_16x16x32_bf16 v[180:183], v[36:39], v[88:91], v[180:183]
    ds_read_b128 v[88:91], v3 offset:14720
    v_mfma_f32_16x16x32_bf16 v[176:179], v[36:39], v[84:87], v[176:179]
    ds_read_b128 v[84:87], v3 offset:13504
    v_mfma_f32_16x16x32_bf16 v[172:175], v[36:39], v[80:83], v[172:175]
    ds_read_b128 v[80:83], v3 offset:12288
    v_mfma_f32_16x16x32_bf16 v[168:171], v[36:39], v[76:79], v[168:171]
    ds_read_b128 v[76:79], v3 offset:11072
    v_mfma_f32_16x16x32_bf16 v[228:231], v[36:39], v[104:107], v[228:231]
    ds_read_b128 v[104:107], v3 offset:19584
    v_mfma_f32_16x16x32_bf16 v[224:227], v[36:39], v[132:135], v[224:227]
    ds_read_b128 v[132:135], v3 offset:28096
    ds_read_b64_tr_b16 v[32:33], v4 offset:12288
    v_mfma_f32_16x16x32_bf16 v[220:223], v[36:39], v[128:131], v[220:223]
    ds_read_b128 v[128:131], v3 offset:26880
    v_mfma_f32_16x16x32_bf16 v[216:219], v[36:39], v[124:127], v[216:219]
    ds_read_b128 v[124:127], v3 offset:25664
    ds_read_b64_tr_b16 v[34:35], v4 offset:12800
    v_mfma_f32_16x16x32_bf16 v[212:215], v[36:39], v[120:123], v[212:215]
    ds_read_b128 v[120:123], v3 offset:24448
    v_xor_b32 v1, s37, v1
    v_mfma_f32_16x16x32_bf16 v[208:211], v[36:39], v[116:119], v[208:211]
    ds_read_b128 v[116:119], v3 offset:23232
    v_xor_b32 v2, s37, v2
    v_mfma_f32_16x16x32_bf16 v[204:207], v[36:39], v[112:115], v[204:207]
    ds_read_b128 v[112:115], v3 offset:22016
    v_mfma_f32_16x16x32_bf16 v[200:203], v[36:39], v[108:111], v[200:203]
    ds_read_b128 v[108:111], v3 offset:20800
    s_sub_u32 s38, s38, 1
    s_cmp_lg_u32 s38, 0
    s_cbranch_scc1 L_cloop
L_cepi:
    v_and_b32 v6, 15, v5
    v_lshrrev_b32 v7, 4, v5
    s_lshl_b32 s39, s30, 2
    v_add_u32 v8, s39, v7
    v_and_b32 v9, 7, v6
    v_lshlrev_b32 v9, 1, v9
    v_xor_b32 v8, v8, v9
    v_lshlrev_b32 v8, 3, v8
    v_lshl_add_u32 v1, v6, 7, v8
    v_add_u32 v1, 131072, v1
    s_nop 4
    s_waitcnt lgkmcnt(0)
    v_pk_add_f32 v[136:137], v[200:201], v[136:137]
    v_pk_add_f32 v[138:139], v[202:203], v[138:139]
    v_pk_add_f32 v[168:169], v[200:201], v[168:169]
    v_pk_add_f32 v[170:171], v[202:203], v[170:171]
    v_pk_add_f32 v[140:141], v[204:205], v[140:141]
    v_pk_add_f32 v[142:143], v[206:207], v[142:143]
    v_pk_add_f32 v[172:173], v[204:205], v[172:173]
    v_pk_add_f32 v[174:175], v[206:207], v[174:175]
    v_pk_add_f32 v[144:145], v[208:209], v[144:145]
    v_pk_add_f32 v[146:147], v[210:211], v[146:147]
    v_pk_add_f32 v[176:177], v[208:209], v[176:177]
    v_pk_add_f32 v[178:179], v[210:211], v[178:179]
    v_pk_add_f32 v[148:149], v[212:213], v[148:149]
    v_pk_add_f32 v[150:151], v[214:215], v[150:151]
    v_pk_add_f32 v[180:181], v[212:213], v[180:181]
    v_pk_add_f32 v[182:183], v[214:215], v[182:183]
    v_cvt_pk_bf16_f32 v8, v136, v137
    v_cvt_pk_bf16_f32 v9, v138, v139
    v_cvt_pk_bf16_f32 v10, v168, v169
    v_cvt_pk_bf16_f32 v11, v170, v171
    v_cvt_pk_bf16_f32 v12, v140, v141
    v_cvt_pk_bf16_f32 v13, v142, v143
    v_cvt_pk_bf16_f32 v14, v172, v173
    v_cvt_pk_bf16_f32 v15, v174, v175
    v_cvt_pk_bf16_f32 v16, v144, v145
    v_cvt_pk_bf16_f32 v17, v146, v147
    v_cvt_pk_bf16_f32 v18, v176, v177
    v_cvt_pk_bf16_f32 v19, v178, v179
    v_cvt_pk_bf16_f32 v20, v148, v149
    v_cvt_pk_bf16_f32 v21, v150, v151
    v_cvt_pk_bf16_f32 v22, v180, v181
    v_cvt_pk_bf16_f32 v23, v182, v183
    ds_write_b64 v1, v[8:9] offset:0
    ds_write_b64 v1, v[10:11] offset:2048
    ds_write_b64 v1, v[12:13] offset:4096
    ds_write_b64 v1, v[14:15] offset:6144
    ds_write_b64 v1, v[16:17] offset:8192
    ds_write_b64 v1, v[18:19] offset:10240
    ds_write_b64 v1, v[20:21] offset:12288
    ds_write_b64 v1, v[22:23] offset:14336
    s_waitcnt lgkmcnt(0)
    s_barrier
    v_pk_add_f32 v[152:153], v[216:217], v[152:153]
    v_pk_add_f32 v[154:155], v[218:219], v[154:155]
    v_pk_add_f32 v[184:185], v[216:217], v[184:185]
    v_pk_add_f32 v[186:187], v[218:219], v[186:187]
    v_pk_add_f32 v[156:157], v[220:221], v[156:157]
    v_pk_add_f32 v[158:159], v[222:223], v[158:159]
    v_pk_add_f32 v[188:189], v[220:221], v[188:189]
    v_pk_add_f32 v[190:191], v[222:223], v[190:191]
    v_pk_add_f32 v[160:161], v[224:225], v[160:161]
    v_pk_add_f32 v[162:163], v[226:227], v[162:163]
    v_pk_add_f32 v[192:193], v[224:225], v[192:193]
    v_pk_add_f32 v[194:195], v[226:227], v[194:195]
    v_pk_add_f32 v[164:165], v[228:229], v[164:165]
    v_pk_add_f32 v[166:167], v[230:231], v[166:167]
    v_pk_add_f32 v[196:197], v[228:229], v[196:197]
    v_pk_add_f32 v[198:199], v[230:231], v[198:199]
    v_cvt_pk_bf16_f32 v24, v152, v153
    v_cvt_pk_bf16_f32 v25, v154, v155
    v_cvt_pk_bf16_f32 v26, v184, v185
    v_cvt_pk_bf16_f32 v27, v186, v187
    v_cvt_pk_bf16_f32 v28, v156, v157
    v_cvt_pk_bf16_f32 v29, v158, v159
    v_cvt_pk_bf16_f32 v30, v188, v189
    v_cvt_pk_bf16_f32 v31, v190, v191
    v_cvt_pk_bf16_f32 v32, v160, v161
    v_cvt_pk_bf16_f32 v33, v162, v163
    v_cvt_pk_bf16_f32 v34, v192, v193
    v_cvt_pk_bf16_f32 v35, v194, v195
    v_cvt_pk_bf16_f32 v36, v164, v165
    v_cvt_pk_bf16_f32 v37, v166, v167
    v_cvt_pk_bf16_f32 v38, v196, v197
    v_cvt_pk_bf16_f32 v39, v198, v199
    ds_write_b64 v1, v[24:25] offset:16384
    ds_write_b64 v1, v[26:27] offset:18432
    ds_write_b64 v1, v[28:29] offset:20480
    ds_write_b64 v1, v[30:31] offset:22528
    ds_write_b64 v1, v[32:33] offset:24576
    ds_write_b64 v1, v[34:35] offset:26624
    ds_write_b64 v1, v[36:37] offset:28672
    ds_write_b64 v1, v[38:39] offset:30720
    s_waitcnt lgkmcnt(0)
    s_branch L_store
L_prod:
    s_cmp_ge_u32 s30, 6
    s_cbranch_scc1 L_aux
    v_lshrrev_b32 v6, 3, v5
    s_lshl_b32 s44, s40, 3
    v_add_u32 v6, s44, v6
    v_and_b32 v7, 7, v5
    v_lshrrev_b32 v8, 1, v6
    v_and_b32 v8, 1, v8
    v_lshrrev_b32 v9, 2, v6
    v_and_b32 v9, 2, v9
    v_or_b32 v8, v9, v8
    v_lshrrev_b32 v9, 1, v7
    v_xor_b32 v8, v8, v9
    v_lshlrev_b32 v8, 5, v8
    v_and_b32 v9, 1, v7
    v_lshl_add_u32 v8, v9, 4, v8
    v_lshl_add_u32 v8, v6, 10, v8
    s_lshl_b32 s44, s28, 7
    v_add_u32 v1, s44, v8
    s_lshl_b32 s42, s40, 10
    s_add_u32 s42, s42, 65536
    s_waitcnt lgkmcnt(0)
    s_mov_b32 s20, s6
    s_mov_b32 s21, s7
    s_mov_b32 s22, 8126464
    s_mov_b32 s23, 0x20000
    s_mov_b32 s24, s14
    s_mov_b32 s25, s15
    s_mov_b32 s26, 16777216
    s_mov_b32 s27, 0x20000
    s_add_u32 s16, s4, s35
    s_addc_u32 s17, s5, 0
    s_mov_b32 s18, 2048000
    s_mov_b32 s19, 0x20000
    v_and_b32 v11, 15, v5
    s_lshl_b32 s44, s40, 4
    v_add_u32 v11, s44, v11
    v_lshlrev_b32 v11, 10, v11
    s_lshl_b32 s44, s28, 7
    v_add_u32 v11, s44, v11
    s_mul_i32 s44, s29, 262144
    buffer_load_dword v12, v11, s[20:23], s44 offen
    s_add_u32 m0, s42, 0
    s_mov_b32 s45, 262144
    buffer_load_dwordx4 v1, s[20:23], s45 offen lds
    s_add_u32 m0, s42, 2048
    s_mov_b32 s45, 278528
    buffer_load_dwordx4 v1, s[20:23], s45 offen lds
    s_add_u32 m0, s42, 4096
    s_mov_b32 s45, 0
    buffer_load_dwordx4 v1, s[20:23], s45 offen lds
    s_add_u32 m0, s42, 6144
    s_mov_b32 s45, 16384
    buffer_load_dwordx4 v1, s[20:23], s45 offen lds
    s_add_u32 m0, s42, 8192
    s_mov_b32 s45, 786432
    buffer_load_dwordx4 v1, s[20:23], s45 offen lds
    s_add_u32 m0, s42, 10240
    s_mov_b32 s45, 802816
    buffer_load_dwordx4 v1, s[20:23], s45 offen lds
    s_add_u32 m0, s42, 12288
    s_mov_b32 s45, 524288
    buffer_load_dwordx4 v1, s[20:23], s45 offen lds
    s_add_u32 m0, s42, 14336
    s_mov_b32 s45, 540672
    buffer_load_dwordx4 v1, s[20:23], s45 offen lds
    s_add_u32 m0, s42, 16384
    s_mov_b32 s45, 1310720
    buffer_load_dwordx4 v1, s[20:23], s45 offen lds
    s_add_u32 m0, s42, 18432
    s_mov_b32 s45, 1327104
    buffer_load_dwordx4 v1, s[20:23], s45 offen lds
    s_add_u32 m0, s42, 20480
    s_mov_b32 s45, 1048576
    buffer_load_dwordx4 v1, s[20:23], s45 offen lds
    s_add_u32 m0, s42, 22528
    s_mov_b32 s45, 1064960
    buffer_load_dwordx4 v1, s[20:23], s45 offen lds
    s_add_u32 m0, s42, 24576
    s_mov_b32 s45, 1835008
    buffer_load_dwordx4 v1, s[20:23], s45 offen lds
    s_add_u32 m0, s42, 26624
    s_mov_b32 s45, 1851392
    buffer_load_dwordx4 v1, s[20:23], s45 offen lds
    s_add_u32 m0, s42, 28672
    s_mov_b32 s45, 1572864
    buffer_load_dwordx4 v1, s[20:23], s45 offen lds
    s_add_u32 m0, s42, 30720
    s_mov_b32 s45, 1589248
    buffer_load_dwordx4 v1, s[20:23], s45 offen lds
    s_mov_b32 s50, 0
    s_mov_b32 s51, 32768
    s_waitcnt vmcnt(8)
    s_barrier
    s_add_u32 m0, s42, 32768
    s_mov_b32 s45, 2359296
    buffer_load_dwordx4 v1, s[20:23], s45 offen lds
    s_add_u32 m0, s42, 34816
    s_mov_b32 s45, 2375680
    buffer_load_dwordx4 v1, s[20:23], s45 offen lds
    s_add_u32 m0, s42, 36864
    s_mov_b32 s45, 2097152
    buffer_load_dwordx4 v1, s[20:23], s45 offen lds
    s_add_u32 m0, s42, 38912
    s_mov_b32 s45, 2113536
    buffer_load_dwordx4 v1, s[20:23], s45 offen lds
    s_add_u32 m0, s42, 40960
    s_mov_b32 s45, 2883584
    buffer_load_dwordx4 v1, s[20:23], s45 offen lds
    s_add_u32 m0, s42, 43008
    s_mov_b32 s45, 2899968
    buffer_load_dwordx4 v1, s[20:23], s45 offen lds
    s_add_u32 m0, s42, 45056
    s_mov_b32 s45, 2621440
    buffer_load_dwordx4 v1, s[20:23], s45 offen lds
    s_add_u32 m0, s42, 47104
    s_mov_b32 s45, 2637824
    buffer_load_dwordx4 v1, s[20:23], s45 offen lds
    s_add_u32 m0, s42, 49152
    s_mov_b32 s45, 3407872
    buffer_load_dwordx4 v1, s[20:23], s45 offen lds
    s_add_u32 m0, s42, 51200
    s_mov_b32 s45, 3424256
    buffer_load_dwordx4 v1, s[20:23], s45 offen lds
    s_add_u32 m0, s42, 53248
    s_mov_b32 s45, 3145728
    buffer_load_dwordx4 v1, s[20:23], s45 offen lds
    s_add_u32 m0, s42, 55296
    s_mov_b32 s45, 3162112
    buffer_load_dwordx4 v1, s[20:23], s45 offen lds
    s_add_u32 m0, s42, 57344
    s_mov_b32 s45, 3932160
    buffer_load_dwordx4 v1, s[20:23], s45 offen lds
    s_add_u32 m0, s42, 59392
    s_mov_b32 s45, 3948544
    buffer_load_dwordx4 v1, s[20:23], s45 offen lds
    s_add_u32 m0, s42, 61440
    s_mov_b32 s45, 3670016
    buffer_load_dwordx4 v1, s[20:23], s45 offen lds
    s_add_u32 m0, s42, 63488
    s_mov_b32 s45, 3686400
    buffer_load_dwordx4 v1, s[20:23], s45 offen lds
    s_waitcnt vmcnt(20)
    s_barrier
    s_add_u32 m0, s42, 0
    s_add_u32 s45, s50, 4456448
    buffer_load_dwordx4 v1, s[20:23], s45 offen lds
    s_add_u32 m0, s42, 2048
    s_add_u32 s45, s50, 4472832
    buffer_load_dwordx4 v1, s[20:23], s45 offen lds
    s_add_u32 m0, s42, 4096
    s_add_u32 s45, s50, 4194304
    buffer_load_dwordx4 v1, s[20:23], s45 offen lds
    s_add_u32 m0, s42, 6144
    s_add_u32 s45, s50, 4210688
    buffer_load_dwordx4 v1, s[20:23], s45 offen lds
    s_waitcnt vmcnt(20)
    s_barrier
    s_add_u32 m0, s42, 8192
    s_add_u32 s45, s50, 4980736
    buffer_load_dwordx4 v1, s[20:23], s45 offen lds
    s_add_u32 m0, s42, 10240
    s_add_u32 s45, s50, 4997120
    buffer_load_dwordx4 v1, s[20:23], s45 offen lds
    s_add_u32 m0, s42, 12288
    s_add_u32 s45, s50, 4718592
    buffer_load_dwordx4 v1, s[20:23], s45 offen lds
    s_add_u32 m0, s42, 14336
    s_add_u32 s45, s50, 4734976
    buffer_load_dwordx4 v1, s[20:23], s45 offen lds
    s_waitcnt vmcnt(20)
    s_barrier
    s_add_u32 m0, s42, 16384
    s_add_u32 s45, s50, 5505024
    buffer_load_dwordx4 v1, s[20:23], s45 offen lds
    s_add_u32 m0, s42, 18432
    s_add_u32 s45, s50, 5521408
    buffer_load_dwordx4 v1, s[20:23], s45 offen lds
    s_add_u32 m0, s42, 20480
    s_add_u32 s45, s50, 5242880
    buffer_load_dwordx4 v1, s[20:23], s45 offen lds
    s_add_u32 m0, s42, 22528
    s_add_u32 s45, s50, 5259264
    buffer_load_dwordx4 v1, s[20:23], s45 offen lds
    s_waitcnt vmcnt(20)
    s_barrier
    s_add_u32 m0, s42, 24576
    s_add_u32 s45, s50, 6029312
    buffer_load_dwordx4 v1, s[20:23], s45 offen lds
    s_add_u32 m0, s42, 26624
    s_add_u32 s45, s50, 6045696
    buffer_load_dwordx4 v1, s[20:23], s45 offen lds
    s_add_u32 m0, s42, 28672
    s_add_u32 s45, s50, 5767168
    buffer_load_dwordx4 v1, s[20:23], s45 offen lds
    s_add_u32 m0, s42, 30720
    s_add_u32 s45, s50, 5783552
    buffer_load_dwordx4 v1, s[20:23], s45 offen lds
    s_waitcnt vmcnt(20)
    s_barrier
    s_add_u32 m0, s42, 32768
    s_add_u32 s45, s50, 6553600
    buffer_load_dwordx4 v1, s[20:23], s45 offen lds
    s_add_u32 m0, s42, 34816
    s_add_u32 s45, s50, 6569984
    buffer_load_dwordx4 v1, s[20:23], s45 offen lds
    s_add_u32 m0, s42, 36864
    s_add_u32 s45, s50, 6291456
    buffer_load_dwordx4 v1, s[20:23], s45 offen lds
    s_add_u32 m0, s42, 38912
    s_add_u32 s45, s50, 6307840
    buffer_load_dwordx4 v1, s[20:23], s45 offen lds
    s_waitcnt vmcnt(20)
    s_barrier
    s_add_u32 m0, s42, 40960
    s_add_u32 s45, s50, 7077888
    buffer_load_dwordx4 v1, s[20:23], s45 offen lds
    s_add_u32 m0, s42, 43008
    s_add_u32 s45, s50, 7094272
    buffer_load_dwordx4 v1, s[20:23], s45 offen lds
    s_add_u32 m0, s42, 45056
    s_add_u32 s45, s50, 6815744
    buffer_load_dwordx4 v1, s[20:23], s45 offen lds
    s_add_u32 m0, s42, 47104
    s_add_u32 s45, s50, 6832128
    buffer_load_dwordx4 v1, s[20:23], s45 offen lds
    s_waitcnt vmcnt(20)
    s_barrier
    s_add_u32 m0, s42, 49152
    s_add_u32 s45, s50, 7602176
    buffer_load_dwordx4 v1, s[20:23], s45 offen lds
    s_add_u32 m0, s42, 51200
    s_add_u32 s45, s50, 7618560
    buffer_load_dwordx4 v1, s[20:23], s45 offen lds
    s_add_u32 m0, s42, 53248
    s_add_u32 s45, s50, 7340032
    buffer_load_dwordx4 v1, s[20:23], s45 offen lds
    s_add_u32 m0, s42, 55296
    s_add_u32 s45, s50, 7356416
    buffer_load_dwordx4 v1, s[20:23], s45 offen lds
    s_waitcnt vmcnt(20)
    s_barrier
    s_add_u32 m0, s42, 61440
    s_add_u32 s45, s50, 7864320
    buffer_load_dwordx4 v1, s[20:23], s45 offen lds
    s_add_u32 m0, s42, 63488
    s_add_u32 s45, s50, 7880704
    buffer_load_dwordx4 v1, s[20:23], s45 offen lds
    s_waitcnt vmcnt(18)
    s_barrier
    s_add_u32 m0, s42, 0
    s_add_u32 s45, s51, 262144
    buffer_load_dwordx4 v1, s[20:23], s45 offen lds
    s_add_u32 m0, s42, 2048
    s_add_u32 s45, s51, 278528
    buffer_load_dwordx4 v1, s[20:23], s45 offen lds
    s_add_u32 m0, s42, 4096
    s_add_u32 s45, s51, 0
    buffer_load_dwordx4 v1, s[20:23], s45 offen lds
    s_add_u32 m0, s42, 6144
    s_add_u32 s45, s51, 16384
    buffer_load_dwordx4 v1, s[20:23], s45 offen lds
    s_waitcnt vmcnt(18)
    s_barrier
    s_add_u32 m0, s42, 8192
    s_add_u32 s45, s51, 786432
    buffer_load_dwordx4 v1, s[20:23], s45 offen lds
    s_add_u32 m0, s42, 10240
    s_add_u32 s45, s51, 802816
    buffer_load_dwordx4 v1, s[20:23], s45 offen lds
    s_add_u32 m0, s42, 12288
    s_add_u32 s45, s51, 524288
    buffer_load_dwordx4 v1, s[20:23], s45 offen lds
    s_add_u32 m0, s42, 14336
    s_add_u32 s45, s51, 540672
    buffer_load_dwordx4 v1, s[20:23], s45 offen lds
    s_waitcnt vmcnt(18)
    s_barrier
    s_add_u32 m0, s42, 16384
    s_add_u32 s45, s51, 1310720
    buffer_load_dwordx4 v1, s[20:23], s45 offen lds
    s_add_u32 m0, s42, 18432
    s_add_u32 s45, s51, 1327104
    buffer_load_dwordx4 v1, s[20:23], s45 offen lds
    s_add_u32 m0, s42, 20480
    s_add_u32 s45, s51, 1048576
    buffer_load_dwordx4 v1, s[20:23], s45 offen lds
    s_add_u32 m0, s42, 22528
    s_add_u32 s45, s51, 1064960
    buffer_load_dwordx4 v1, s[20:23], s45 offen lds
    s_waitcnt vmcnt(18)
    s_barrier
    s_add_u32 m0, s42, 24576
    s_add_u32 s45, s51, 1835008
    buffer_load_dwordx4 v1, s[20:23], s45 offen lds
    s_add_u32 m0, s42, 26624
    s_add_u32 s45, s51, 1851392
    buffer_load_dwordx4 v1, s[20:23], s45 offen lds
    s_add_u32 m0, s42, 28672
    s_add_u32 s45, s51, 1572864
    buffer_load_dwordx4 v1, s[20:23], s45 offen lds
    s_add_u32 m0, s42, 30720
    s_add_u32 s45, s51, 1589248
    buffer_load_dwordx4 v1, s[20:23], s45 offen lds
    s_waitcnt vmcnt(18)
    s_barrier
    s_add_u32 m0, s42, 32768
    s_add_u32 s45, s51, 2359296
    buffer_load_dwordx4 v1, s[20:23], s45 offen lds
    s_add_u32 m0, s42, 34816
    s_add_u32 s45, s51, 2375680
    buffer_load_dwordx4 v1, s[20:23], s45 offen lds
    s_add_u32 m0, s42, 36864
    s_add_u32 s45, s51, 2097152
    buffer_load_dwordx4 v1, s[20:23], s45 offen lds
    s_add_u32 m0, s42, 38912
    s_add_u32 s45, s51, 2113536
    buffer_load_dwordx4 v1, s[20:23], s45 offen lds
    s_waitcnt vmcnt(20)
    s_barrier
    s_add_u32 m0, s42, 40960
    s_add_u32 s45, s51, 2883584
    buffer_load_dwordx4 v1, s[20:23], s45 offen lds
    s_add_u32 m0, s42, 43008
    s_add_u32 s45, s51, 2899968
    buffer_load_dwordx4 v1, s[20:23], s45 offen lds
    s_add_u32 m0, s42, 45056
    s_add_u32 s45, s51, 2621440
    buffer_load_dwordx4 v1, s[20:23], s45 offen lds
    s_add_u32 m0, s42, 47104
    s_add_u32 s45, s51, 2637824
    buffer_load_dwordx4 v1, s[20:23], s45 offen lds
    s_waitcnt vmcnt(20)
    s_barrier
    s_add_u32 m0, s42, 49152
    s_add_u32 s45, s51, 3407872
    buffer_load_dwordx4 v1, s[20:23], s45 offen lds
    s_add_u32 m0, s42, 51200
    s_add_u32 s45, s51, 3424256
    buffer_load_dwordx4 v1, s[20:23], s45 offen lds
    s_add_u32 m0, s42, 53248
    s_add_u32 s45, s51, 3145728
    buffer_load_dwordx4 v1, s[20:23], s45 offen lds
    s_add_u32 m0, s42, 55296
    s_add_u32 s45, s51, 3162112
    buffer_load_dwordx4 v1, s[20:23], s45 offen lds
    s_waitcnt vmcnt(20)
    s_barrier
    s_add_u32 m0, s42, 57344
    s_add_u32 s45, s51, 3932160
    buffer_load_dwordx4 v1, s[20:23], s45 offen lds
    s_add_u32 m0, s42, 59392
    s_add_u32 s45, s51, 3948544
    buffer_load_dwordx4 v1, s[20:23], s45 offen lds
    s_add_u32 m0, s42, 61440
    s_add_u32 s45, s51, 3670016
    buffer_load_dwordx4 v1, s[20:23], s45 offen lds
    s_add_u32 m0, s42, 63488
    s_add_u32 s45, s51, 3686400
    buffer_load_dwordx4 v1, s[20:23], s45 offen lds
    s_mov_b32 s50, s51
    s_add_u32 s51, s51, 32768
    s_waitcnt vmcnt(20)
    s_mov_b32 s38, 6
L_wloop:
    s_barrier
    s_add_u32 m0, s42, 0
    s_add_u32 s45, s50, 4456448
    buffer_load_dwordx4 v1, s[20:23], s45 offen lds
    s_add_u32 m0, s42, 2048
    s_add_u32 s45, s50, 4472832
    buffer_load_dwordx4 v1, s[20:23], s45 offen lds
    s_add_u32 m0, s42, 4096
    s_add_u32 s45, s50, 4194304
    buffer_load_dwordx4 v1, s[20:23], s45 offen lds
    s_add_u32 m0, s42, 6144
    s_add_u32 s45, s50, 4210688
    buffer_load_dwordx4 v1, s[20:23], s45 offen lds
    s_waitcnt vmcnt(20)
    s_barrier
    s_add_u32 m0, s42, 8192
    s_add_u32 s45, s50, 4980736
    buffer_load_dwordx4 v1, s[20:23], s45 offen lds
    s_add_u32 m0, s42, 10240
    s_add_u32 s45, s50, 4997120
    buffer_load_dwordx4 v1, s[20:23], s45 offen lds
    s_add_u32 m0, s42, 12288
    s_add_u32 s45, s50, 4718592
    buffer_load_dwordx4 v1, s[20:23], s45 offen lds
    s_add_u32 m0, s42, 14336
    s_add_u32 s45, s50, 4734976
    buffer_load_dwordx4 v1, s[20:23], s45 offen lds
    s_waitcnt vmcnt(20)
    s_barrier
    s_add_u32 m0, s42, 16384
    s_add_u32 s45, s50, 5505024
    buffer_load_dwordx4 v1, s[20:23], s45 offen lds
    s_add_u32 m0, s42, 18432
    s_add_u32 s45, s50, 5521408
    buffer_load_dwordx4 v1, s[20:23], s45 offen lds
    s_add_u32 m0, s42, 20480
    s_add_u32 s45, s50, 5242880
    buffer_load_dwordx4 v1, s[20:23], s45 offen lds
    s_add_u32 m0, s42, 22528
    s_add_u32 s45, s50, 5259264
    buffer_load_dwordx4 v1, s[20:23], s45 offen lds
    s_waitcnt vmcnt(20)
    s_barrier
    s_add_u32 m0, s42, 24576
    s_add_u32 s45, s50, 6029312
    buffer_load_dwordx4 v1, s[20:23], s45 offen lds
    s_add_u32 m0, s42, 26624
    s_add_u32 s45, s50, 6045696
    buffer_load_dwordx4 v1, s[20:23], s45 offen lds
    s_add_u32 m0, s42, 28672
    s_add_u32 s45, s50, 5767168
    buffer_load_dwordx4 v1, s[20:23], s45 offen lds
    s_add_u32 m0, s42, 30720
    s_add_u32 s45, s50, 5783552
    buffer_load_dwordx4 v1, s[20:23], s45 offen lds
    s_waitcnt vmcnt(20)
    s_barrier
    s_add_u32 m0, s42, 32768
    s_add_u32 s45, s50, 6553600
    buffer_load_dwordx4 v1, s[20:23], s45 offen lds
    s_add_u32 m0, s42, 34816
    s_add_u32 s45, s50, 6569984
    buffer_load_dwordx4 v1, s[20:23], s45 offen lds
    s_add_u32 m0, s42, 36864
    s_add_u32 s45, s50, 6291456
    buffer_load_dwordx4 v1, s[20:23], s45 offen lds
    s_add_u32 m0, s42, 38912
    s_add_u32 s45, s50, 6307840
    buffer_load_dwordx4 v1, s[20:23], s45 offen lds
    s_waitcnt vmcnt(20)
    s_barrier
    s_add_u32 m0, s42, 40960
    s_add_u32 s45, s50, 7077888
    buffer_load_dwordx4 v1, s[20:23], s45 offen lds
    s_add_u32 m0, s42, 43008
    s_add_u32 s45, s50, 7094272
    buffer_load_dwordx4 v1, s[20:23], s45 offen lds
    s_add_u32 m0, s42, 45056
    s_add_u32 s45, s50, 6815744
    buffer_load_dwordx4 v1, s[20:23], s45 offen lds
    s_add_u32 m0, s42, 47104
    s_add_u32 s45, s50, 6832128
    buffer_load_dwordx4 v1, s[20:23], s45 offen lds
    s_waitcnt vmcnt(20)
    s_barrier
    s_add_u32 m0, s42, 49152
    s_add_u32 s45, s50, 7602176
    buffer_load_dwordx4 v1, s[20:23], s45 offen lds
    s_add_u32 m0, s42, 51200
    s_add_u32 s45, s50, 7618560
    buffer_load_dwordx4 v1, s[20:23], s45 offen lds
    s_add_u32 m0, s42, 53248
    s_add_u32 s45, s50, 7340032
    buffer_load_dwordx4 v1, s[20:23], s45 offen lds
    s_add_u32 m0, s42, 55296
    s_add_u32 s45, s50, 7356416
    buffer_load_dwordx4 v1, s[20:23], s45 offen lds
    s_waitcnt vmcnt(20)
    s_barrier
    s_add_u32 m0, s42, 61440
    s_add_u32 s45, s50, 7864320
    buffer_load_dwordx4 v1, s[20:23], s45 offen lds
    s_add_u32 m0, s42, 63488
    s_add_u32 s45, s50, 7880704
    buffer_load_dwordx4 v1, s[20:23], s45 offen lds
    s_waitcnt vmcnt(18)
    s_barrier
    s_add_u32 m0, s42, 0
    s_add_u32 s45, s51, 262144
    buffer_load_dwordx4 v1, s[20:23], s45 offen lds
    s_add_u32 m0, s42, 2048
    s_add_u32 s45, s51, 278528
    buffer_load_dwordx4 v1, s[20:23], s45 offen lds
    s_add_u32 m0, s42, 4096
    s_add_u32 s45, s51, 0
    buffer_load_dwordx4 v1, s[20:23], s45 offen lds
    s_add_u32 m0, s42, 6144
    s_add_u32 s45, s51, 16384
    buffer_load_dwordx4 v1, s[20:23], s45 offen lds
    s_waitcnt vmcnt(18)
    s_barrier
    s_add_u32 m0, s42, 8192
    s_add_u32 s45, s51, 786432
    buffer_load_dwordx4 v1, s[20:23], s45 offen lds
    s_add_u32 m0, s42, 10240
    s_add_u32 s45, s51, 802816
    buffer_load_dwordx4 v1, s[20:23], s45 offen lds
    s_add_u32 m0, s42, 12288
    s_add_u32 s45, s51, 524288
    buffer_load_dwordx4 v1, s[20:23], s45 offen lds
    s_add_u32 m0, s42, 14336
    s_add_u32 s45, s51, 540672
    buffer_load_dwordx4 v1, s[20:23], s45 offen lds
    s_waitcnt vmcnt(18)
    s_barrier
    s_add_u32 m0, s42, 16384
    s_add_u32 s45, s51, 1310720
    buffer_load_dwordx4 v1, s[20:23], s45 offen lds
    s_add_u32 m0, s42, 18432
    s_add_u32 s45, s51, 1327104
    buffer_load_dwordx4 v1, s[20:23], s45 offen lds
    s_add_u32 m0, s42, 20480
    s_add_u32 s45, s51, 1048576
    buffer_load_dwordx4 v1, s[20:23], s45 offen lds
    s_add_u32 m0, s42, 22528
    s_add_u32 s45, s51, 1064960
    buffer_load_dwordx4 v1, s[20:23], s45 offen lds
    s_waitcnt vmcnt(18)
    s_barrier
    s_add_u32 m0, s42, 24576
    s_add_u32 s45, s51, 1835008
    buffer_load_dwordx4 v1, s[20:23], s45 offen lds
    s_add_u32 m0, s42, 26624
    s_add_u32 s45, s51, 1851392
    buffer_load_dwordx4 v1, s[20:23], s45 offen lds
    s_add_u32 m0, s42, 28672
    s_add_u32 s45, s51, 1572864
    buffer_load_dwordx4 v1, s[20:23], s45 offen lds
    s_add_u32 m0, s42, 30720
    s_add_u32 s45, s51, 1589248
    buffer_load_dwordx4 v1, s[20:23], s45 offen lds
    s_waitcnt vmcnt(18)
    s_barrier
    s_add_u32 m0, s42, 32768
    s_add_u32 s45, s51, 2359296
    buffer_load_dwordx4 v1, s[20:23], s45 offen lds
    s_add_u32 m0, s42, 34816
    s_add_u32 s45, s51, 2375680
    buffer_load_dwordx4 v1, s[20:23], s45 offen lds
    s_add_u32 m0, s42, 36864
    s_add_u32 s45, s51, 2097152
    buffer_load_dwordx4 v1, s[20:23], s45 offen lds
    s_add_u32 m0, s42, 38912
    s_add_u32 s45, s51, 2113536
    buffer_load_dwordx4 v1, s[20:23], s45 offen lds
    s_waitcnt vmcnt(20)
    s_barrier
    s_add_u32 m0, s42, 40960
    s_add_u32 s45, s51, 2883584
    buffer_load_dwordx4 v1, s[20:23], s45 offen lds
    s_add_u32 m0, s42, 43008
    s_add_u32 s45, s51, 2899968
    buffer_load_dwordx4 v1, s[20:23], s45 offen lds
    s_add_u32 m0, s42, 45056
    s_add_u32 s45, s51, 2621440
    buffer_load_dwordx4 v1, s[20:23], s45 offen lds
    s_add_u32 m0, s42, 47104
    s_add_u32 s45, s51, 2637824
    buffer_load_dwordx4 v1, s[20:23], s45 offen lds
    s_waitcnt vmcnt(20)
    s_barrier
    s_add_u32 m0, s42, 49152
    s_add_u32 s45, s51, 3407872
    buffer_load_dwordx4 v1, s[20:23], s45 offen lds
    s_add_u32 m0, s42, 51200
    s_add_u32 s45, s51, 3424256
    buffer_load_dwordx4 v1, s[20:23], s45 offen lds
    s_add_u32 m0, s42, 53248
    s_add_u32 s45, s51, 3145728
    buffer_load_dwordx4 v1, s[20:23], s45 offen lds
    s_add_u32 m0, s42, 55296
    s_add_u32 s45, s51, 3162112
    buffer_load_dwordx4 v1, s[20:23], s45 offen lds
    s_waitcnt vmcnt(20)
    s_barrier
    s_add_u32 m0, s42, 57344
    s_add_u32 s45, s51, 3932160
    buffer_load_dwordx4 v1, s[20:23], s45 offen lds
    s_add_u32 m0, s42, 59392
    s_add_u32 s45, s51, 3948544
    buffer_load_dwordx4 v1, s[20:23], s45 offen lds
    s_add_u32 m0, s42, 61440
    s_add_u32 s45, s51, 3670016
    buffer_load_dwordx4 v1, s[20:23], s45 offen lds
    s_add_u32 m0, s42, 63488
    s_add_u32 s45, s51, 3686400
    buffer_load_dwordx4 v1, s[20:23], s45 offen lds
    s_mov_b32 s50, s51
    s_add_u32 s51, s51, 32768
    s_waitcnt vmcnt(20)
    s_sub_u32 s38, s38, 1
    s_cmp_lg_u32 s38, 0
    s_cbranch_scc1 L_wloop
    v_mov_b32 v13, 30720
    ds_read_b32 v12, v13
    s_waitcnt lgkmcnt(0)
    v_readfirstlane_b32 s94, v12
    s_mov_b32 s52, s8
    s_mov_b32 s53, s9
    s_mov_b32 s54, 131072
    s_mov_b32 s55, 0x20000
    s_and_b32 s40, s30, 3
    s_lshl_b32 s56, s40, 10
    v_lshrrev_b32 v12, 5, v5
    s_and_b32 s44, s40, 1
    s_lshl_b32 s44, s44, 1
    v_add_u32 v13, s44, v12
    v_lshlrev_b32 v13, 2, v13
    v_and_b32 v8, 31, v5
    v_xor_b32 v8, v8, v13
    v_lshlrev_b32 v8, 4, v8
    v_lshl_add_u32 v8, v12, 9, v8
    s_barrier
    s_add_u32 m0, s42, 0
    s_add_u32 s45, s50, 4456448
    buffer_load_dwordx4 v1, s[20:23], s45 offen lds
    s_add_u32 m0, s42, 2048
    s_add_u32 s45, s50, 4472832
    buffer_load_dwordx4 v1, s[20:23], s45 offen lds
    s_add_u32 m0, s42, 4096
    s_add_u32 s45, s50, 4194304
    buffer_load_dwordx4 v1, s[20:23], s45 offen lds
    s_add_u32 m0, s42, 6144
    s_add_u32 s45, s50, 4210688
    buffer_load_dwordx4 v1, s[20:23], s45 offen lds
    s_add_u32 m0, s56, 0
    s_add_u32 s45, s56, 0
    buffer_load_dwordx4 v8, s[52:55], s45 offen lds
    s_waitcnt vmcnt(21)
    s_barrier
    s_add_u32 m0, s42, 8192
    s_add_u32 s45, s50, 4980736
    buffer_load_dwordx4 v1, s[20:23], s45 offen lds
    s_add_u32 m0, s42, 10240
    s_add_u32 s45, s50, 4997120
    buffer_load_dwordx4 v1, s[20:23], s45 offen lds
    s_add_u32 m0, s42, 12288
    s_add_u32 s45, s50, 4718592
    buffer_load_dwordx4 v1, s[20:23], s45 offen lds
    s_add_u32 m0, s42, 14336
    s_add_u32 s45, s50, 4734976
    buffer_load_dwordx4 v1, s[20:23], s45 offen lds
    s_add_u32 m0, s56, 4096
    s_add_u32 s45, s56, 4096
    buffer_load_dwordx4 v8, s[52:55], s45 offen lds
    s_waitcnt vmcnt(22)
    s_barrier
    s_add_u32 m0, s42, 16384
    s_add_u32 s45, s50, 5505024
    buffer_load_dwordx4 v1, s[20:23], s45 offen lds
    s_add_u32 m0, s42, 18432
    s_add_u32 s45, s50, 5521408
    buffer_load_dwordx4 v1, s[20:23], s45 offen lds
    s_add_u32 m0, s42, 20480
    s_add_u32 s45, s50, 5242880
    buffer_load_dwordx4 v1, s[20:23], s45 offen lds
    s_add_u32 m0, s42, 22528
    s_add_u32 s45, s50, 5259264
    buffer_load_dwordx4 v1, s[20:23], s45 offen lds
    s_add_u32 m0, s56, 8192
    s_add_u32 s45, s56, 8192
    buffer_load_dwordx4 v8, s[52:55], s45 offen lds
    s_waitcnt vmcnt(23)
    s_barrier
    s_add_u32 m0, s42, 24576
    s_add_u32 s45, s50, 6029312
    buffer_load_dwordx4 v1, s[20:23], s45 offen lds
    s_add_u32 m0, s42, 26624
    s_add_u32 s45, s50, 6045696
    buffer_load_dwordx4 v1, s[20:23], s45 offen lds
    s_add_u32 m0, s42, 28672
    s_add_u32 s45, s50, 5767168
    buffer_load_dwordx4 v1, s[20:23], s45 offen lds
    s_add_u32 m0, s42, 30720
    s_add_u32 s45, s50, 5783552
    buffer_load_dwordx4 v1, s[20:23], s45 offen lds
    s_add_u32 m0, s56, 12288
    s_add_u32 s45, s56, 12288
    buffer_load_dwordx4 v8, s[52:55], s45 offen lds
    s_waitcnt vmcnt(24)
    s_barrier
    s_add_u32 m0, s42, 32768
    s_add_u32 s45, s50, 6553600
    buffer_load_dwordx4 v1, s[20:23], s45 offen lds
    s_add_u32 m0, s42, 34816
    s_add_u32 s45, s50, 6569984
    buffer_load_dwordx4 v1, s[20:23], s45 offen lds
    s_add_u32 m0, s42, 36864
    s_add_u32 s45, s50, 6291456
    buffer_load_dwordx4 v1, s[20:23], s45 offen lds
    s_add_u32 m0, s42, 38912
    s_add_u32 s45, s50, 6307840
    buffer_load_dwordx4 v1, s[20:23], s45 offen lds
    s_add_u32 m0, s56, 16384
    s_add_u32 s45, s56, 16384
    buffer_load_dwordx4 v8, s[52:55], s45 offen lds
    s_waitcnt vmcnt(25)
    s_barrier
    s_add_u32 m0, s42, 40960
    s_add_u32 s45, s50, 7077888
    buffer_load_dwordx4 v1, s[20:23], s45 offen lds
    s_add_u32 m0, s42, 43008
    s_add_u32 s45, s50, 7094272
    buffer_load_dwordx4 v1, s[20:23], s45 offen lds
    s_add_u32 m0, s42, 45056
    s_add_u32 s45, s50, 6815744
    buffer_load_dwordx4 v1, s[20:23], s45 offen lds
    s_add_u32 m0, s42, 47104
    s_add_u32 s45, s50, 6832128
    buffer_load_dwordx4 v1, s[20:23], s45 offen lds
    s_add_u32 m0, s56, 20480
    s_add_u32 s45, s56, 20480
    buffer_load_dwordx4 v8, s[52:55], s45 offen lds
    s_waitcnt vmcnt(26)
    s_barrier
    s_add_u32 m0, s42, 49152
    s_add_u32 s45, s50, 7602176
    buffer_load_dwordx4 v1, s[20:23], s45 offen lds
    s_add_u32 m0, s42, 51200
    s_add_u32 s45, s50, 7618560
    buffer_load_dwordx4 v1, s[20:23], s45 offen lds
    s_add_u32 m0, s42, 53248
    s_add_u32 s45, s50, 7340032
    buffer_load_dwordx4 v1, s[20:23], s45 offen lds
    s_add_u32 m0, s42, 55296
    s_add_u32 s45, s50, 7356416
    buffer_load_dwordx4 v1, s[20:23], s45 offen lds
    s_add_u32 m0, s56, 24576
    s_add_u32 s45, s56, 24576
    buffer_load_dwordx4 v8, s[52:55], s45 offen lds
    s_waitcnt vmcnt(26)
    s_barrier
    s_add_u32 m0, s42, 61440
    s_add_u32 s45, s50, 7864320
    buffer_load_dwordx4 v1, s[20:23], s45 offen lds
    s_add_u32 m0, s42, 63488
    s_add_u32 s45, s50, 7880704
    buffer_load_dwordx4 v1, s[20:23], s45 offen lds
    s_add_u32 m0, s56, 28672
    s_add_u32 s45, s56, 28672
    buffer_load_dwordx4 v8, s[52:55], s45 offen lds
    s_waitcnt vmcnt(24)
    s_barrier
    s_add_u32 m0, s56, 65536
    s_add_u32 s45, s56, 65536
    buffer_load_dwordx4 v8, s[52:55], s45 offen lds
    s_add_u32 m0, s56, 69632
    s_add_u32 s45, s56, 69632
    buffer_load_dwordx4 v8, s[52:55], s45 offen lds
    s_waitcnt vmcnt(21)
    s_barrier
    s_add_u32 m0, s56, 73728
    s_add_u32 s45, s56, 73728
    buffer_load_dwordx4 v8, s[52:55], s45 offen lds
    s_add_u32 m0, s56, 77824
    s_add_u32 s45, s56, 77824
    buffer_load_dwordx4 v8, s[52:55], s45 offen lds
    s_waitcnt vmcnt(18)
    s_barrier
    s_add_u32 m0, s56, 81920
    s_add_u32 s45, s56, 81920
    buffer_load_dwordx4 v8, s[52:55], s45 offen lds
    s_add_u32 m0, s56, 86016
    s_add_u32 s45, s56, 86016
    buffer_load_dwordx4 v8, s[52:55], s45 offen lds
    s_waitcnt vmcnt(15)
    s_barrier
    s_add_u32 m0, s56, 90112
    s_add_u32 s45, s56, 90112
    buffer_load_dwordx4 v8, s[52:55], s45 offen lds
    s_add_u32 m0, s56, 94208
    s_add_u32 s45, s56, 94208
    buffer_load_dwordx4 v8, s[52:55], s45 offen lds
    s_waitcnt vmcnt(12)
    s_barrier
    s_add_u32 m0, s56, 98304
    s_add_u32 s45, s56, 98304
    buffer_load_dwordx4 v8, s[52:55], s45 offen lds
    s_add_u32 m0, s56, 102400
    s_add_u32 s45, s56, 102400
    buffer_load_dwordx4 v8, s[52:55], s45 offen lds
    s_waitcnt vmcnt(11)
    s_barrier
    s_add_u32 m0, s56, 106496
    s_add_u32 s45, s56, 106496
    buffer_load_dwordx4 v8, s[52:55], s45 offen lds
    s_add_u32 m0, s56, 110592
    s_add_u32 s45, s56, 110592
    buffer_load_dwordx4 v8, s[52:55], s45 offen lds
    s_barrier
    s_add_u32 m0, s56, 114688
    s_add_u32 s45, s56, 114688
    buffer_load_dwordx4 v8, s[52:55], s45 offen lds
    s_add_u32 m0, s56, 118784
    s_add_u32 s45, s56, 118784
    buffer_load_dwordx4 v8, s[52:55], s45 offen lds
    s_barrier
    s_add_u32 m0, s56, 122880
    s_add_u32 s45, s56, 122880
    buffer_load_dwordx4 v8, s[52:55], s45 offen lds
    s_add_u32 m0, s56, 126976
    s_add_u32 s45, s56, 126976
    buffer_load_dwordx4 v8, s[52:55], s45 offen lds
    s_add_u32 m0, s56, 32768
    s_add_u32 s45, s56, 32768
    buffer_load_dwordx4 v8, s[52:55], s45 offen lds
    s_add_u32 m0, s56, 36864
    s_add_u32 s45, s56, 36864
    buffer_load_dwordx4 v8, s[52:55], s45 offen lds
    s_add_u32 m0, s56, 40960
    s_add_u32 s45, s56, 40960
    buffer_load_dwordx4 v8, s[52:55], s45 offen lds
    s_add_u32 m0, s56, 45056
    s_add_u32 s45, s56, 45056
    buffer_load_dwordx4 v8, s[52:55], s45 offen lds
    s_add_u32 m0, s56, 49152
    s_add_u32 s45, s56, 49152
    buffer_load_dwordx4 v8, s[52:55], s45 offen lds
    s_add_u32 m0, s56, 53248
    s_add_u32 s45, s56, 53248
    buffer_load_dwordx4 v8, s[52:55], s45 offen lds
    s_add_u32 m0, s56, 57344
    s_add_u32 s45, s56, 57344
    buffer_load_dwordx4 v8, s[52:55], s45 offen lds
    s_add_u32 m0, s56, 61440
    s_add_u32 s45, s56, 61440
    buffer_load_dwordx4 v8, s[52:55], s45 offen lds
    s_branch L_store_p
L_aux:
    s_and_b32 s40, s30, 1
    v_mov_b32 v83, 0x40000000
    s_lshl_b32 s45, s33, 9
    s_add_u32 s45, s45, 128
    s_mul_i32 s46, s28, 1216
    s_lshl_b32 s44, s29, 18
    s_add_u32 s46, s46, s44
    s_add_u32 s46, s46, 8454144
    s_add_u32 s44, s31, s28
    s_sub_u32 s44, s44, 16
    s_movk_i32 s55, 911
    v_and_b32 v10, 3, v5
    s_add_u32 s41, s40, 0
    s_lshl_b32 s41, s41, 6
    v_add_u32 v11, s41, v5
    v_mul_u32_u24 v12, s55, v11
    v_lshrrev_b32 v12, 16, v12
    v_mul_u32_u24 v13, 72, v12
    v_sub_u32 v13, v11, v13
    v_lshrrev_b32 v13, 2, v13
    v_lshl_add_u32 v14, v13, 3, s44
    v_lshlrev_b32 v15, 11, v14
    v_lshl_add_u32 v15, v12, 6, v15
    v_lshl_add_u32 v15, v10, 4, v15
    v_add_u32 v15, s45, v15
    v_add_u32 v82, 0xfffffc00, v15
    v_cmp_gt_i32 s[48:49], 0, v14
    v_cmp_gt_i32 s[50:51], 1, v14
    v_cmp_le_u32 vcc, 0x1b0, v11
    v_lshrrev_b32 v14, 1, v13
    v_and_b32 v14, 2, v14
    s_or_b64 s[48:49], s[48:49], vcc
    s_or_b64 s[50:51], s[50:51], vcc
    v_xor_b32 v14, v14, v10
    v_cndmask_b32 v65, v15, v83, s[48:49]
    v_cndmask_b32 v64, v82, v83, s[50:51]
    v_lshlrev_b32 v14, 4, v14
    v_lshl_add_u32 v14, v13, 6, v14
    v_lshl_add_u32 v14, v12, 15, v14
    v_add_u32 v14, s46, v14
    v_cndmask_b32 v72, v14, v83, vcc
    s_add_u32 s41, s40, 2
    s_lshl_b32 s41, s41, 6
    v_add_u32 v11, s41, v5
    v_mul_u32_u24 v12, s55, v11
    v_lshrrev_b32 v12, 16, v12
    v_mul_u32_u24 v13, 72, v12
    v_sub_u32 v13, v11, v13
    v_lshrrev_b32 v13, 2, v13
    v_lshl_add_u32 v14, v13, 3, s44
    v_lshlrev_b32 v15, 11, v14
    v_lshl_add_u32 v15, v12, 6, v15
    v_lshl_add_u32 v15, v10, 4, v15
    v_add_u32 v15, s45, v15
    v_add_u32 v82, 0xfffffc00, v15
    v_cmp_gt_i32 s[48:49], 0, v14
    v_cmp_gt_i32 s[50:51], 1, v14
    v_cmp_le_u32 vcc, 0x1b0, v11
    v_lshrrev_b32 v14, 1, v13
    v_and_b32 v14, 2, v14
    s_or_b64 s[48:49], s[48:49], vcc
    s_or_b64 s[50:51], s[50:51], vcc
    v_xor_b32 v14, v14, v10
    v_cndmask_b32 v67, v15, v83, s[48:49]
    v_cndmask_b32 v66, v82, v83, s[50:51]
    v_lshlrev_b32 v14, 4, v14
    v_lshl_add_u32 v14, v13, 6, v14
    v_lshl_add_u32 v14, v12, 15, v14
    v_add_u32 v14, s46, v14
    v_cndmask_b32 v73, v14, v83, vcc
    s_add_u32 s41, s40, 4
    s_lshl_b32 s41, s41, 6
    v_add_u32 v11, s41, v5
    v_mul_u32_u24 v12, s55, v11
    v_lshrrev_b32 v12, 16, v12
    v_mul_u32_u24 v13, 72, v12
    v_sub_u32 v13, v11, v13
    v_lshrrev_b32 v13, 2, v13
    v_lshl_add_u32 v14, v13, 3, s44
    v_lshlrev_b32 v15, 11, v14
    v_lshl_add_u32 v15, v12, 6, v15
    v_lshl_add_u32 v15, v10, 4, v15
    v_add_u32 v15, s45, v15
    v_add_u32 v82, 0xfffffc00, v15
    v_cmp_gt_i32 s[48:49], 0, v14
    v_cmp_gt_i32 s[50:51], 1, v14
    v_cmp_le_u32 vcc, 0x1b0, v11
    v_lshrrev_b32 v14, 1, v13
    v_and_b32 v14, 2, v14
    s_or_b64 s[48:49], s[48:49], vcc
    s_or_b64 s[50:51], s[50:51], vcc
    v_xor_b32 v14, v14, v10
    v_cndmask_b32 v69, v15, v83, s[48:49]
    v_cndmask_b32 v68, v82, v83, s[50:51]
    v_lshlrev_b32 v14, 4, v14
    v_lshl_add_u32 v14, v13, 6, v14
    v_lshl_add_u32 v14, v12, 15, v14
    v_add_u32 v14, s46, v14
    v_cndmask_b32 v74, v14, v83, vcc
    s_add_u32 s41, s40, 6
    s_lshl_b32 s41, s41, 6
    v_add_u32 v11, s41, v5
    v_mul_u32_u24 v12, s55, v11
    v_lshrrev_b32 v12, 16, v12
    v_mul_u32_u24 v13, 72, v12
    v_sub_u32 v13, v11, v13
    v_lshrrev_b32 v13, 2, v13
    v_lshl_add_u32 v14, v13, 3, s44
    v_lshlrev_b32 v15, 11, v14
    v_lshl_add_u32 v15, v12, 6, v15
    v_lshl_add_u32 v15, v10, 4, v15
    v_add_u32 v15, s45, v15
    v_add_u32 v82, 0xfffffc00, v15
    v_cmp_gt_i32 s[48:49], 0, v14
    v_cmp_gt_i32 s[50:51], 1, v14
    v_cmp_le_u32 vcc, 0x1b0, v11
    v_lshrrev_b32 v14, 1, v13
    v_and_b32 v14, 2, v14
    s_or_b64 s[48:49], s[48:49], vcc
    s_or_b64 s[50:51], s[50:51], vcc
    v_xor_b32 v14, v14, v10
    v_cndmask_b32 v71, v15, v83, s[48:49]
    v_cndmask_b32 v70, v82, v83, s[50:51]
    v_lshlrev_b32 v14, 4, v14
    v_lshl_add_u32 v14, v13, 6, v14
    v_lshl_add_u32 v14, v12, 15, v14
    v_add_u32 v14, s46, v14
    v_cndmask_b32 v75, v14, v83, vcc
    v_and_b32 v11, 15, v5
    s_lshl_b32 s44, s40, 4
    v_add_u32 v11, s44, v11
    v_lshlrev_b32 v11, 10, v11
    s_lshl_b32 s44, s28, 7
    v_add_u32 v11, s44, v11
    s_mul_i32 s44, s29, 262144
    v_add_u32 v82, s44, v11
    s_mov_b32 s90, 32768
    s_and_b32 s44, s29, 15
    s_lshl_b32 s44, s44, 1
    s_add_u32 s44, s44, s40
    s_lshl_b32 s44, s44, 5
    v_and_b32 v83, 31, v5
    v_add_u32 v83, s44, v83
    v_lshlrev_b32 v83, 7, v83
    v_lshlrev_b32 v2, 4, v5
    s_lshl_b32 s56, s40, 10
    s_lshl_b32 s57, s29, 18
    s_add_u32 s57, s57, s56
    s_add_u32 s57, s57, 8454144
    s_mov_b32 s58, s56
    s_getreg_b32 s93, hwreg(HW_REG_XCC_ID)
    s_and_b32 s93, s93, 15
    v_mov_b32 v86, 0
    s_lshl_b32 s59, s29, 3
    s_add_u32 s59, s59, s28
    s_lshl_b32 s59, s59, 7
    s_add_u32 s59, s59, 17825792
    v_mov_b32 v84, s59
    v_and_b32 v85, 7, v5
    s_lshl_b32 s59, s29, 10
    s_add_u32 s59, s59, 17825792
    v_lshl_add_u32 v85, v85, 7, s59
    v_and_b32 v11, 31, v5
    v_lshlrev_b32 v11, 7, v11
    s_lshl_b32 s44, s29, 18
    s_lshl_b32 s45, s28, 12
    s_add_u32 s44, s44, s45
    s_lshl_b32 s45, s40, 17
    s_add_u32 s44, s44, s45
    v_add_u32 v76, s44, v11
    s_mov_b32 s95, 0
    v_lshrrev_b32 v11, 2, v5
    v_lshlrev_b32 v11, 3, v11
    s_add_u32 s44, s31, s28
    v_add_u32 v11, s44, v11
    v_lshlrev_b32 v11, 11, v11
    v_and_b32 v12, 3, v5
    v_lshl_add_u32 v11, v12, 7, v11
    s_lshl_b32 s44, s33, 9
    s_lshl_b32 s45, s40, 10
    s_add_u32 s44, s44, s45
    v_add_u32 v77, s44, v11
    s_waitcnt lgkmcnt(0)
    s_add_u32 s16, s4, s35
    s_addc_u32 s17, s5, 0
    s_mov_b32 s18, 2048000
    s_mov_b32 s19, 0x20000
    s_mov_b32 s20, s6
    s_mov_b32 s21, s7
    s_mov_b32 s22, 8126464
    s_mov_b32 s23, 0x20000
    s_mov_b32 s24, s14
    s_mov_b32 s25, s15
    s_mov_b32 s26, 16777216
    s_mov_b32 s27, 0x20000
    buffer_load_dwordx4 v[16:19], v64, s[16:19], 0 offen
    buffer_load_dwordx4 v[20:23], v65, s[16:19], 0 offen
    buffer_load_dwordx4 v[24:27], v65, s[16:19], 0 offen offset:1024
    buffer_load_dwordx4 v[28:31], v66, s[16:19], 0 offen
    buffer_load_dwordx4 v[32:35], v67, s[16:19], 0 offen
    buffer_load_dwordx4 v[36:39], v67, s[16:19], 0 offen offset:1024
    buffer_load_dwordx4 v[40:43], v68, s[16:19], 0 offen
    buffer_load_dwordx4 v[44:47], v69, s[16:19], 0 offen
    buffer_load_dwordx4 v[48:51], v69, s[16:19], 0 offen offset:1024
    buffer_load_dwordx4 v[52:55], v70, s[16:19], 0 offen
    buffer_load_dwordx4 v[56:59], v71, s[16:19], 0 offen
    buffer_load_dwordx4 v[60:63], v71, s[16:19], 0 offen offset:1024
    s_cmp_lg_u32 s2, 0
    s_cbranch_scc1 L_nononce
    s_cmp_lg_u32 s30, 6
    s_cbranch_scc1 L_nononce
    s_memrealtime s[46:47]
    s_waitcnt lgkmcnt(0)
    s_and_b32 s46, s46, 0xfffffff0
    s_or_b32 s46, s46, 16
    v_mov_b32 v7, s46
    s_mov_b64 exec, 1
    global_store_dword v86, v7, s[12:13] sc1
    s_mov_b64 exec, -1
L_nononce:
    s_barrier
    s_waitcnt vmcnt(9)
    v_lshlrev_b32 v88, 16, v20
    v_and_b32 v89, s36, v20
    v_lshlrev_b32 v90, 16, v24
    v_and_b32 v91, s36, v24
    v_lshlrev_b32 v92, 16, v16
    v_and_b32 v93, s36, v16
    v_sub_f32 v90, v90, v88
    v_sub_f32 v91, v91, v89
    v_sub_f32 v92, v92, v88
    v_sub_f32 v93, v93, v89
    v_cvt_pk_bf16_f32 v132, v90, v91
    v_cvt_pk_bf16_f32 v128, v92, v93
    v_lshlrev_b32 v94, 16, v21
    v_and_b32 v95, s36, v21
    v_lshlrev_b32 v96, 16, v25
    v_and_b32 v97, s36, v25
    v_lshlrev_b32 v98, 16, v17
    v_and_b32 v99, s36, v17
    v_sub_f32 v96, v96, v94
    v_sub_f32 v97, v97, v95
    v_sub_f32 v98, v98, v94
    v_sub_f32 v99, v99, v95
    v_cvt_pk_bf16_f32 v133, v96, v97
    v_cvt_pk_bf16_f32 v129, v98, v99
    v_lshlrev_b32 v88, 16, v22
    v_and_b32 v89, s36, v22
    v_lshlrev_b32 v90, 16, v26
    v_and_b32 v91, s36, v26
    v_lshlrev_b32 v92, 16, v18
    v_and_b32 v93, s36, v18
    v_sub_f32 v90, v90, v88
    v_sub_f32 v91, v91, v89
    v_sub_f32 v92, v92, v88
    v_sub_f32 v93, v93, v89
    v_cvt_pk_bf16_f32 v134, v90, v91
    v_cvt_pk_bf16_f32 v130, v92, v93
    v_lshlrev_b32 v94, 16, v23
    v_and_b32 v95, s36, v23
    v_lshlrev_b32 v96, 16, v27
    v_and_b32 v97, s36, v27
    v_lshlrev_b32 v98, 16, v19
    v_and_b32 v99, s36, v19
    v_sub_f32 v96, v96, v94
    v_sub_f32 v97, v97, v95
    v_sub_f32 v98, v98, v94
    v_sub_f32 v99, v99, v95
    v_cvt_pk_bf16_f32 v135, v96, v97
    v_cvt_pk_bf16_f32 v131, v98, v99
    s_waitcnt vmcnt(6)
    v_lshlrev_b32 v88, 16, v32
    v_and_b32 v89, s36, v32
    v_lshlrev_b32 v90, 16, v36
    v_and_b32 v91, s36, v36
    v_lshlrev_b32 v92, 16, v28
    v_and_b32 v93, s36, v28
    v_sub_f32 v90, v90, v88
    v_sub_f32 v91, v91, v89
    v_sub_f32 v92, v92, v88
    v_sub_f32 v93, v93, v89
    v_cvt_pk_bf16_f32 v140, v90, v91
    v_cvt_pk_bf16_f32 v136, v92, v93
    v_lshlrev_b32 v94, 16, v33
    v_and_b32 v95, s36, v33
    v_lshlrev_b32 v96, 16, v37
    v_and_b32 v97, s36, v37
    v_lshlrev_b32 v98, 16, v29
    v_and_b32 v99, s36, v29
    v_sub_f32 v96, v96, v94
    v_sub_f32 v97, v97, v95
    v_sub_f32 v98, v98, v94
    v_sub_f32 v99, v99, v95
    v_cvt_pk_bf16_f32 v141, v96, v97
    v_cvt_pk_bf16_f32 v137, v98, v99
    v_lshlrev_b32 v88, 16, v34
    v_and_b32 v89, s36, v34
    v_lshlrev_b32 v90, 16, v38
    v_and_b32 v91, s36, v38
    v_lshlrev_b32 v92, 16, v30
    v_and_b32 v93, s36, v30
    v_sub_f32 v90, v90, v88
    v_sub_f32 v91, v91, v89
    v_sub_f32 v92, v92, v88
    v_sub_f32 v93, v93, v89
    v_cvt_pk_bf16_f32 v142, v90, v91
    v_cvt_pk_bf16_f32 v138, v92, v93
    v_lshlrev_b32 v94, 16, v35
    v_and_b32 v95, s36, v35
    v_lshlrev_b32 v96, 16, v39
    v_and_b32 v97, s36, v39
    v_lshlrev_b32 v98, 16, v31
    v_and_b32 v99, s36, v31
    v_sub_f32 v96, v96, v94
    v_sub_f32 v97, v97, v95
    v_sub_f32 v98, v98, v94
    v_sub_f32 v99, v99, v95
    v_cvt_pk_bf16_f32 v143, v96, v97
    v_cvt_pk_bf16_f32 v139, v98, v99
    s_waitcnt vmcnt(3)
    v_lshlrev_b32 v88, 16, v44
    v_and_b32 v89, s36, v44
    v_lshlrev_b32 v90, 16, v48
    v_and_b32 v91, s36, v48
    v_lshlrev_b32 v92, 16, v40
    v_and_b32 v93, s36, v40
    v_sub_f32 v90, v90, v88
    v_sub_f32 v91, v91, v89
    v_sub_f32 v92, v92, v88
    v_sub_f32 v93, v93, v89
    v_cvt_pk_bf16_f32 v148, v90, v91
    v_cvt_pk_bf16_f32 v144, v92, v93
    v_lshlrev_b32 v94, 16, v45
    v_and_b32 v95, s36, v45
    v_lshlrev_b32 v96, 16, v49
    v_and_b32 v97, s36, v49
    v_lshlrev_b32 v98, 16, v41
    v_and_b32 v99, s36, v41
    v_sub_f32 v96, v96, v94
    v_sub_f32 v97, v97, v95
    v_sub_f32 v98, v98, v94
    v_sub_f32 v99, v99, v95
    v_cvt_pk_bf16_f32 v149, v96, v97
    v_cvt_pk_bf16_f32 v145, v98, v99
    v_lshlrev_b32 v88, 16, v46
    v_and_b32 v89, s36, v46
    v_lshlrev_b32 v90, 16, v50
    v_and_b32 v91, s36, v50
    v_lshlrev_b32 v92, 16, v42
    v_and_b32 v93, s36, v42
    v_sub_f32 v90, v90, v88
    v_sub_f32 v91, v91, v89
    v_sub_f32 v92, v92, v88
    v_sub_f32 v93, v93, v89
    v_cvt_pk_bf16_f32 v150, v90, v91
    v_cvt_pk_bf16_f32 v146, v92, v93
    v_lshlrev_b32 v94, 16, v47
    v_and_b32 v95, s36, v47
    v_lshlrev_b32 v96, 16, v51
    v_and_b32 v97, s36, v51
    v_lshlrev_b32 v98, 16, v43
    v_and_b32 v99, s36, v43
    v_sub_f32 v96, v96, v94
    v_sub_f32 v97, v97, v95
    v_sub_f32 v98, v98, v94
    v_sub_f32 v99, v99, v95
    v_cvt_pk_bf16_f32 v151, v96, v97
    v_cvt_pk_bf16_f32 v147, v98, v99
    s_barrier
    s_waitcnt vmcnt(0)
    v_lshlrev_b32 v88, 16, v56
    v_and_b32 v89, s36, v56
    v_lshlrev_b32 v90, 16, v60
    v_and_b32 v91, s36, v60
    v_lshlrev_b32 v92, 16, v52
    v_and_b32 v93, s36, v52
    v_sub_f32 v90, v90, v88
    v_sub_f32 v91, v91, v89
    v_sub_f32 v92, v92, v88
    v_sub_f32 v93, v93, v89
    v_cvt_pk_bf16_f32 v156, v90, v91
    v_cvt_pk_bf16_f32 v152, v92, v93
    v_lshlrev_b32 v94, 16, v57
    v_and_b32 v95, s36, v57
    v_lshlrev_b32 v96, 16, v61
    v_and_b32 v97, s36, v61
    v_lshlrev_b32 v98, 16, v53
    v_and_b32 v99, s36, v53
    v_sub_f32 v96, v96, v94
    v_sub_f32 v97, v97, v95
    v_sub_f32 v98, v98, v94
    v_sub_f32 v99, v99, v95
    v_cvt_pk_bf16_f32 v157, v96, v97
    v_cvt_pk_bf16_f32 v153, v98, v99
    s_mov_b32 s45, 9728
    s_mov_b32 s46, 19456
    buffer_store_dwordx4 v[128:131], v72, s[24:27], 0 offen sc1
    buffer_store_dwordx4 v[132:135], v72, s[24:27], s45 offen sc1
    buffer_store_dwordx4 v[20:23], v72, s[24:27], s46 offen sc1
    s_barrier
    v_lshlrev_b32 v88, 16, v58
    v_and_b32 v89, s36, v58
    v_lshlrev_b32 v90, 16, v62
    v_and_b32 v91, s36, v62
    v_lshlrev_b32 v92, 16, v54
    v_and_b32 v93, s36, v54
    v_sub_f32 v90, v90, v88
    v_sub_f32 v91, v91, v89
    v_sub_f32 v92, v92, v88
    v_sub_f32 v93, v93, v89
    v_cvt_pk_bf16_f32 v158, v90, v91
    v_cvt_pk_bf16_f32 v154, v92, v93
    v_lshlrev_b32 v94, 16, v59
    v_and_b32 v95, s36, v59
    v_lshlrev_b32 v96, 16, v63
    v_and_b32 v97, s36, v63
    v_lshlrev_b32 v98, 16, v55
    v_and_b32 v99, s36, v55
    v_sub_f32 v96, v96, v94
    v_sub_f32 v97, v97, v95
    v_sub_f32 v98, v98, v94
    v_sub_f32 v99, v99, v95
    v_cvt_pk_bf16_f32 v159, v96, v97
    v_cvt_pk_bf16_f32 v155, v98, v99
    s_barrier
    s_mov_b32 s45, 9728
    s_mov_b32 s46, 19456
    buffer_store_dwordx4 v[136:139], v73, s[24:27], 0 offen sc1
    buffer_store_dwordx4 v[140:143], v73, s[24:27], s45 offen sc1
    buffer_store_dwordx4 v[32:35], v73, s[24:27], s46 offen sc1
    s_barrier
    buffer_load_dword v119, v82, s[20:23], s90 offen
    s_add_u32 s90, s90, 32768
    s_barrier
    s_mov_b32 s45, 9728
    s_mov_b32 s46, 19456
    buffer_store_dwordx4 v[144:147], v74, s[24:27], 0 offen sc1
    buffer_store_dwordx4 v[148:151], v74, s[24:27], s45 offen sc1
    buffer_store_dwordx4 v[44:47], v74, s[24:27], s46 offen sc1
    s_barrier
    s_barrier
    s_mov_b32 s45, 9728
    s_mov_b32 s46, 19456
    buffer_store_dwordx4 v[152:155], v75, s[24:27], 0 offen sc1
    buffer_store_dwordx4 v[156:159], v75, s[24:27], s45 offen sc1
    buffer_store_dwordx4 v[56:59], v75, s[24:27], s46 offen sc1
    s_barrier
    s_barrier
    s_barrier
    global_load_dword v87, v86, s[12:13] sc1
    s_barrier
    s_waitcnt vmcnt(0)
    v_readfirstlane_b32 s47, v87
    s_cmp_lg_u32 s47, 0
    s_cbranch_scc1 L_nok
    s_mov_b32 s46, 0x100000
L_nspin:
    s_sleep 2
    global_load_dword v87, v86, s[12:13] sc1
    s_waitcnt vmcnt(0)
    v_readfirstlane_b32 s47, v87
    s_sub_u32 s46, s46, 1
    s_cmp_eq_u32 s46, 0
    s_cbranch_scc1 L_nok
    s_cmp_eq_u32 s47, 0
    s_cbranch_scc1 L_nspin
L_nok:
    s_waitcnt vmcnt(1)
    s_barrier
    s_cmp_lg_u32 s30, 6
    s_cbranch_scc1 L_nosig
    s_or_b32 s44, s47, s93
    v_mov_b32 v11, s44
    s_mov_b64 exec, 1
    global_store_dword v84, v11, s[14:15] sc1
    s_mov_b64 exec, -1
L_nosig:
    s_barrier
    global_load_dword v118, v83, s[8:9]
    s_barrier
    s_barrier
    global_load_dword v87, v85, s[14:15] sc1
    s_barrier
    s_waitcnt vmcnt(0)
    v_and_b32 v12, -16, v87
    v_cmp_eq_u32 vcc, s47, v12
    s_nop 1
    s_cmp_eq_u64 vcc, -1
    s_cbranch_scc1 L_xok
    s_mov_b32 s46, 0x100000
L_xspin:
    s_sleep 2
    global_load_dword v87, v85, s[14:15] sc1
    s_waitcnt vmcnt(0)
    v_and_b32 v12, -16, v87
    v_cmp_eq_u32 vcc, s47, v12
    s_sub_u32 s46, s46, 1
    s_cmp_eq_u32 s46, 0
    s_cbranch_scc1 L_xok
    s_cmp_eq_u64 vcc, -1
    s_cbranch_scc0 L_xspin
L_xok:
    s_or_b32 s44, s47, s93
    v_cmp_eq_u32 vcc, s44, v87
    s_mov_b32 s94, 0
    s_nop 0
    s_cmp_eq_u64 vcc, -1
    s_cselect_b32 s94, 1, 0
    v_mov_b32 v12, s94
    v_mov_b32 v13, s47
    v_mov_b32 v14, 30720
    ds_write_b64 v14, v[12:13]
    s_waitcnt lgkmcnt(0)
    s_mov_b32 s38, 6
L_aloop:
    s_barrier
    s_barrier
    s_add_u32 m0, s58, 0
    s_add_u32 s45, s57, 0
    buffer_load_dwordx4 v2, s[24:27], s45 offen sc1 lds
    s_add_u32 m0, s58, 2048
    s_add_u32 s45, s57, 2048
    buffer_load_dwordx4 v2, s[24:27], s45 offen sc1 lds
    s_barrier
    s_add_u32 m0, s58, 4096
    s_add_u32 s45, s57, 4096
    buffer_load_dwordx4 v2, s[24:27], s45 offen sc1 lds
    s_add_u32 m0, s58, 6144
    s_add_u32 s45, s57, 6144
    buffer_load_dwordx4 v2, s[24:27], s45 offen sc1 lds
    s_barrier
    buffer_load_dword v119, v82, s[20:23], s90 offen
    s_add_u32 s90, s90, 32768
    s_add_u32 m0, s58, 8192
    s_add_u32 s45, s57, 8192
    buffer_load_dwordx4 v2, s[24:27], s45 offen sc1 lds
    s_add_u32 m0, s58, 10240
    s_add_u32 s45, s57, 10240
    buffer_load_dwordx4 v2, s[24:27], s45 offen sc1 lds
    s_barrier
    s_add_u32 m0, s58, 12288
    s_add_u32 s45, s57, 12288
    buffer_load_dwordx4 v2, s[24:27], s45 offen sc1 lds
    s_add_u32 m0, s58, 14336
    s_add_u32 s45, s57, 14336
    buffer_load_dwordx4 v2, s[24:27], s45 offen sc1 lds
    s_barrier
    s_add_u32 m0, s58, 16384
    s_add_u32 s45, s57, 16384
    buffer_load_dwordx4 v2, s[24:27], s45 offen sc1 lds
    s_add_u32 m0, s58, 18432
    s_add_u32 s45, s57, 18432
    buffer_load_dwordx4 v2, s[24:27], s45 offen sc1 lds
    s_barrier
    s_add_u32 m0, s58, 20480
    s_add_u32 s45, s57, 20480
    buffer_load_dwordx4 v2, s[24:27], s45 offen sc1 lds
    s_add_u32 m0, s58, 22528
    s_add_u32 s45, s57, 22528
    buffer_load_dwordx4 v2, s[24:27], s45 offen sc1 lds
    s_barrier
    s_add_u32 m0, s58, 24576
    s_add_u32 s45, s57, 24576
    buffer_load_dwordx4 v2, s[24:27], s45 offen sc1 lds
    s_add_u32 m0, s58, 26624
    s_add_u32 s45, s57, 26624
    buffer_load_dwordx4 v2, s[24:27], s45 offen sc1 lds
    s_barrier
    s_add_u32 m0, s58, 28672
    s_add_u32 s45, s57, 28672
    buffer_load_dwordx4 v2, s[24:27], s45 offen sc1 lds
    s_barrier
    s_cmp_gt_u32 s38, 2
    s_cbranch_scc1 L_nowt9
    buffer_load_dword v117, v76, s[24:27], s95 offen
    s_add_u32 s95, s95, 32768
L_nowt9:
    s_barrier
    s_barrier
    s_barrier
    s_barrier
    s_waitcnt vmcnt(0)
    s_barrier
    s_cmp_gt_u32 s38, 2
    s_cbranch_scc1 L_nowt14
    buffer_load_dword v117, v76, s[24:27], s95 offen
    s_add_u32 s95, s95, 32768
L_nowt14:
    s_barrier
    s_add_u32 s57, s57, 32768
    s_xor_b32 s58, s58, 32768
    s_sub_u32 s38, s38, 1
    s_cmp_lg_u32 s38, 0
    s_cbranch_scc1 L_aloop
    s_mov_b32 s52, s8
    s_mov_b32 s53, s9
    s_mov_b32 s54, 131072
    s_mov_b32 s55, 0x20000
    s_and_b32 s40, s30, 3
    s_lshl_b32 s56, s40, 10
    v_lshrrev_b32 v12, 5, v5
    s_and_b32 s44, s40, 1
    s_lshl_b32 s44, s44, 1
    v_add_u32 v13, s44, v12
    v_lshlrev_b32 v13, 2, v13
    v_and_b32 v8, 31, v5
    v_xor_b32 v8, v8, v13
    v_lshlrev_b32 v8, 4, v8
    v_lshl_add_u32 v8, v12, 9, v8
    s_barrier
    s_add_u32 m0, s56, 0
    s_add_u32 s45, s56, 0
    buffer_load_dwordx4 v8, s[52:55], s45 offen lds
    s_barrier
    s_add_u32 m0, s56, 4096
    s_add_u32 s45, s56, 4096
    buffer_load_dwordx4 v8, s[52:55], s45 offen lds
    s_barrier
    s_add_u32 m0, s56, 8192
    s_add_u32 s45, s56, 8192
    buffer_load_dwordx4 v8, s[52:55], s45 offen lds
    s_barrier
    s_add_u32 m0, s56, 12288
    s_add_u32 s45, s56, 12288
    buffer_load_dwordx4 v8, s[52:55], s45 offen lds
    s_barrier
    s_add_u32 m0, s56, 16384
    s_add_u32 s45, s56, 16384
    buffer_load_dwordx4 v8, s[52:55], s45 offen lds
    s_barrier
    s_add_u32 m0, s56, 20480
    s_add_u32 s45, s56, 20480
    buffer_load_dwordx4 v8, s[52:55], s45 offen lds
    s_barrier
    s_add_u32 m0, s56, 24576
    s_add_u32 s45, s56, 24576
    buffer_load_dwordx4 v8, s[52:55], s45 offen lds
    s_barrier
    s_add_u32 m0, s56, 28672
    s_add_u32 s45, s56, 28672
    buffer_load_dwordx4 v8, s[52:55], s45 offen lds
    s_barrier
    s_add_u32 m0, s56, 65536
    s_add_u32 s45, s56, 65536
    buffer_load_dwordx4 v8, s[52:55], s45 offen lds
    s_add_u32 m0, s56, 69632
    s_add_u32 s45, s56, 69632
    buffer_load_dwordx4 v8, s[52:55], s45 offen lds
    s_barrier
    s_add_u32 m0, s56, 73728
    s_add_u32 s45, s56, 73728
    buffer_load_dwordx4 v8, s[52:55], s45 offen lds
    s_add_u32 m0, s56, 77824
    s_add_u32 s45, s56, 77824
    buffer_load_dwordx4 v8, s[52:55], s45 offen lds
    s_barrier
    s_add_u32 m0, s56, 81920
    s_add_u32 s45, s56, 81920
    buffer_load_dwordx4 v8, s[52:55], s45 offen lds
    s_add_u32 m0, s56, 86016
    s_add_u32 s45, s56, 86016
    buffer_load_dwordx4 v8, s[52:55], s45 offen lds
    s_barrier
    s_add_u32 m0, s56, 90112
    s_add_u32 s45, s56, 90112
    buffer_load_dwordx4 v8, s[52:55], s45 offen lds
    s_add_u32 m0, s56, 94208
    s_add_u32 s45, s56, 94208
    buffer_load_dwordx4 v8, s[52:55], s45 offen lds
    s_barrier
    s_add_u32 m0, s56, 98304
    s_add_u32 s45, s56, 98304
    buffer_load_dwordx4 v8, s[52:55], s45 offen lds
    s_add_u32 m0, s56, 102400
    s_add_u32 s45, s56, 102400
    buffer_load_dwordx4 v8, s[52:55], s45 offen lds
    s_barrier
    s_add_u32 m0, s56, 106496
    s_add_u32 s45, s56, 106496
    buffer_load_dwordx4 v8, s[52:55], s45 offen lds
    s_add_u32 m0, s56, 110592
    s_add_u32 s45, s56, 110592
    buffer_load_dwordx4 v8, s[52:55], s45 offen lds
    s_barrier
    s_add_u32 m0, s56, 114688
    s_add_u32 s45, s56, 114688
    buffer_load_dwordx4 v8, s[52:55], s45 offen lds
    s_add_u32 m0, s56, 118784
    s_add_u32 s45, s56, 118784
    buffer_load_dwordx4 v8, s[52:55], s45 offen lds
    s_barrier
    s_add_u32 m0, s56, 122880
    s_add_u32 s45, s56, 122880
    buffer_load_dwordx4 v8, s[52:55], s45 offen lds
    s_add_u32 m0, s56, 126976
    s_add_u32 s45, s56, 126976
    buffer_load_dwordx4 v8, s[52:55], s45 offen lds
    s_add_u32 m0, s56, 32768
    s_add_u32 s45, s56, 32768
    buffer_load_dwordx4 v8, s[52:55], s45 offen lds
    s_add_u32 m0, s56, 36864
    s_add_u32 s45, s56, 36864
    buffer_load_dwordx4 v8, s[52:55], s45 offen lds
    s_add_u32 m0, s56, 40960
    s_add_u32 s45, s56, 40960
    buffer_load_dwordx4 v8, s[52:55], s45 offen lds
    s_add_u32 m0, s56, 45056
    s_add_u32 s45, s56, 45056
    buffer_load_dwordx4 v8, s[52:55], s45 offen lds
    s_add_u32 m0, s56, 49152
    s_add_u32 s45, s56, 49152
    buffer_load_dwordx4 v8, s[52:55], s45 offen lds
    s_add_u32 m0, s56, 53248
    s_add_u32 s45, s56, 53248
    buffer_load_dwordx4 v8, s[52:55], s45 offen lds
    s_add_u32 m0, s56, 57344
    s_add_u32 s45, s56, 57344
    buffer_load_dwordx4 v8, s[52:55], s45 offen lds
    s_add_u32 m0, s56, 61440
    s_add_u32 s45, s56, 61440
    buffer_load_dwordx4 v8, s[52:55], s45 offen lds
L_store_p:
    v_and_b32 v1, 7, v5
    v_lshrrev_b32 v2, 3, v5
    s_and_b32 s40, s30, 3
    s_lshl_b32 s41, s40, 3
    v_add_u32 v2, s41, v2
    v_and_b32 v3, 7, v2
    v_xor_b32 v3, v3, v1
    v_lshlrev_b32 v3, 4, v3
    v_lshl_add_u32 v3, v2, 7, v3
    v_add_u32 v3, 131072, v3
    v_lshlrev_b32 v4, 7, v2
    v_lshl_add_u32 v4, v1, 4, v4
    s_lshl_b32 s39, s29, 18
    s_lshl_b32 s40, s28, 12
    s_add_u32 s39, s39, s40
    s_barrier
    ds_read_b128 v[16:19], v3 offset:0
    ds_read_b128 v[20:23], v3 offset:4096
    ds_read_b128 v[24:27], v3 offset:8192
    ds_read_b128 v[28:31], v3 offset:12288
    s_cmp_eq_u32 s94, 1
    s_cbranch_scc1 L_hfast0
    s_waitcnt lgkmcnt(3)
    s_add_u32 s41, s39, 0
    buffer_store_dwordx4 v[16:19], v4, s[24:27], s41 offen sc1
    s_waitcnt lgkmcnt(2)
    s_add_u32 s41, s39, 32768
    buffer_store_dwordx4 v[20:23], v4, s[24:27], s41 offen sc1
    s_waitcnt lgkmcnt(1)
    s_add_u32 s41, s39, 65536
    buffer_store_dwordx4 v[24:27], v4, s[24:27], s41 offen sc1
    s_waitcnt lgkmcnt(0)
    s_add_u32 s41, s39, 98304
    buffer_store_dwordx4 v[28:31], v4, s[24:27], s41 offen sc1
    s_branch L_hs0
L_hfast0:
    s_waitcnt lgkmcnt(3)
    s_add_u32 s41, s39, 0
    buffer_store_dwordx4 v[16:19], v4, s[24:27], s41 offen nt
    s_waitcnt lgkmcnt(2)
    s_add_u32 s41, s39, 32768
    buffer_store_dwordx4 v[20:23], v4, s[24:27], s41 offen nt
    s_waitcnt lgkmcnt(1)
    s_add_u32 s41, s39, 65536
    buffer_store_dwordx4 v[24:27], v4, s[24:27], s41 offen nt
    s_waitcnt lgkmcnt(0)
    s_add_u32 s41, s39, 98304
    buffer_store_dwordx4 v[28:31], v4, s[24:27], s41 offen nt
L_hs0:
    s_waitcnt vmcnt(14)
    s_barrier
    ds_read_b128 v[32:35], v3 offset:16384
    ds_read_b128 v[36:39], v3 offset:20480
    ds_read_b128 v[40:43], v3 offset:24576
    ds_read_b128 v[44:47], v3 offset:28672
    s_cmp_eq_u32 s94, 1
    s_cbranch_scc1 L_hfast1
    s_waitcnt lgkmcnt(3)
    s_add_u32 s41, s39, 131072
    buffer_store_dwordx4 v[32:35], v4, s[24:27], s41 offen sc1
    s_waitcnt lgkmcnt(2)
    s_add_u32 s41, s39, 163840
    buffer_store_dwordx4 v[36:39], v4, s[24:27], s41 offen sc1
    s_waitcnt lgkmcnt(1)
    s_add_u32 s41, s39, 196608
    buffer_store_dwordx4 v[40:43], v4, s[24:27], s41 offen sc1
    s_waitcnt lgkmcnt(0)
    s_add_u32 s41, s39, 229376
    buffer_store_dwordx4 v[44:47], v4, s[24:27], s41 offen sc1
    s_branch L_hs1
L_hfast1:
    s_waitcnt lgkmcnt(3)
    s_add_u32 s41, s39, 131072
    buffer_store_dwordx4 v[32:35], v4, s[24:27], s41 offen nt
    s_waitcnt lgkmcnt(2)
    s_add_u32 s41, s39, 163840
    buffer_store_dwordx4 v[36:39], v4, s[24:27], s41 offen nt
    s_waitcnt lgkmcnt(1)
    s_add_u32 s41, s39, 196608
    buffer_store_dwordx4 v[40:43], v4, s[24:27], s41 offen nt
    s_waitcnt lgkmcnt(0)
    s_add_u32 s41, s39, 229376
    buffer_store_dwordx4 v[44:47], v4, s[24:27], s41 offen nt
L_hs1:
    s_waitcnt vmcnt(0)
    s_barrier
    v_and_b32 v6, 15, v5
    v_lshrrev_b32 v7, 4, v5
    v_lshrrev_b32 v8, 2, v6
    v_and_b32 v13, 3, v6
    s_lshl_b32 s44, s30, 2
    v_add_u32 v10, s44, v13
    v_lshlrev_b32 v11, 2, v8
    v_xor_b32 v10, v10, v11
    v_lshlrev_b32 v10, 4, v10
    v_lshl_add_u32 v11, v7, 3, v8
    v_lshl_add_u32 v10, v11, 9, v10
    v_add_u32 v12, 0x10000, v10
    ds_read_b64_tr_b16 v[128:129], v10 offset:0
    ds_read_b64_tr_b16 v[130:131], v10 offset:2048
    ds_read_b64_tr_b16 v[132:133], v10 offset:8
    ds_read_b64_tr_b16 v[134:135], v10 offset:2056
    ds_read_b64_tr_b16 v[136:137], v10 offset:16384
    ds_read_b64_tr_b16 v[138:139], v10 offset:18432
    ds_read_b64_tr_b16 v[140:141], v10 offset:16392
    ds_read_b64_tr_b16 v[142:143], v10 offset:18440
    ds_read_b64_tr_b16 v[144:145], v10 offset:32768
    ds_read_b64_tr_b16 v[146:147], v10 offset:34816
    ds_read_b64_tr_b16 v[148:149], v10 offset:32776
    ds_read_b64_tr_b16 v[150:151], v10 offset:34824
    ds_read_b64_tr_b16 v[152:153], v10 offset:49152
    ds_read_b64_tr_b16 v[154:155], v10 offset:51200
    ds_read_b64_tr_b16 v[156:157], v10 offset:49160
    ds_read_b64_tr_b16 v[158:159], v10 offset:51208
    ds_read_b64_tr_b16 v[160:161], v12 offset:0
    ds_read_b64_tr_b16 v[162:163], v12 offset:2048
    ds_read_b64_tr_b16 v[164:165], v12 offset:8
    ds_read_b64_tr_b16 v[166:167], v12 offset:2056
    ds_read_b64_tr_b16 v[168:169], v12 offset:16384
    ds_read_b64_tr_b16 v[170:171], v12 offset:18432
    ds_read_b64_tr_b16 v[172:173], v12 offset:16392
    ds_read_b64_tr_b16 v[174:175], v12 offset:18440
    ds_read_b64_tr_b16 v[176:177], v12 offset:32768
    ds_read_b64_tr_b16 v[178:179], v12 offset:34816
    ds_read_b64_tr_b16 v[180:181], v12 offset:32776
    ds_read_b64_tr_b16 v[182:183], v12 offset:34824
    ds_read_b64_tr_b16 v[184:185], v12 offset:49152
    ds_read_b64_tr_b16 v[186:187], v12 offset:51200
    ds_read_b64_tr_b16 v[188:189], v12 offset:49160
    ds_read_b64_tr_b16 v[190:191], v12 offset:51208
    s_add_u32 s96, s10, s35
    s_addc_u32 s97, s11, 0
    s_mov_b32 s98, 2048000
    s_mov_b32 s99, 0x20000
    v_lshrrev_b32 v2, 4, v0
    v_and_b32 v3, 15, v0
    v_lshrrev_b32 v4, 3, v3
    v_lshlrev_b32 v4, 12, v4
    v_lshl_add_u32 v4, v2, 7, v4
    v_and_b32 v14, 7, v3
    v_lshl_add_u32 v4, v14, 4, v4
    s_lshl_b32 s88, s29, 18
    s_lshl_b32 s89, s28, 15
    s_add_u32 s88, s88, s89
    s_add_u32 s89, s88, 8192
    s_add_u32 s91, s88, 16384
    s_add_u32 s92, s88, 24576
    s_mov_b32 s48, 0xc038aa3b
    s_mov_b32 s49, 0xc038aa3b
    s_mov_b32 s50, 0xbfb8aa3b
    s_mov_b32 s51, 0xbfb8aa3b
    s_mov_b32 s52, 1.0
    s_mov_b32 s53, 1.0
    s_mov_b32 s43, 0x42700000
    v_mul_u32_u24 v9, 528, v2
    v_lshl_add_u32 v9, v3, 4, v9
    v_add_u32 v9, 131072, v9
    v_mul_u32_u24 v11, 528, v6
    v_lshl_add_u32 v11, v7, 4, v11
    v_add_u32 v11, 131072, v11
    v_lshlrev_b32 v8, 3, v6
    s_add_u32 s44, s31, s28
    v_add_u32 v8, s44, v8
    v_lshlrev_b32 v8, 11, v8
    s_lshl_b32 s44, s33, 9
    s_lshl_b32 s45, s30, 6
    s_add_u32 s44, s44, s45
    v_add_u32 v8, s44, v8
    v_lshl_add_u32 v8, v7, 4, v8
    v_mov_b32 v14, 0xc2700000
    s_branch L_hwait
L_store:
    s_barrier
    v_readfirstlane_b32 s94, v246
    v_readfirstlane_b32 s47, v247
    v_and_b32 v6, 15, v5
    v_lshrrev_b32 v7, 4, v5
    v_lshrrev_b32 v8, 2, v6
    v_and_b32 v13, 3, v6
    s_lshl_b32 s44, s30, 2
    v_add_u32 v10, s44, v13
    v_lshlrev_b32 v11, 2, v8
    v_xor_b32 v10, v10, v11
    v_lshlrev_b32 v10, 4, v10
    v_lshl_add_u32 v11, v7, 3, v8
    v_lshl_add_u32 v10, v11, 9, v10
    v_add_u32 v12, 0x10000, v10
    ds_read_b64_tr_b16 v[128:129], v10 offset:0
    ds_read_b64_tr_b16 v[130:131], v10 offset:2048
    ds_read_b64_tr_b16 v[132:133], v10 offset:8
    ds_read_b64_tr_b16 v[134:135], v10 offset:2056
    ds_read_b64_tr_b16 v[136:137], v10 offset:16384
    ds_read_b64_tr_b16 v[138:139], v10 offset:18432
    ds_read_b64_tr_b16 v[140:141], v10 offset:16392
    ds_read_b64_tr_b16 v[142:143], v10 offset:18440
    ds_read_b64_tr_b16 v[160:161], v12 offset:0
    ds_read_b64_tr_b16 v[162:163], v12 offset:2048
    ds_read_b64_tr_b16 v[164:165], v12 offset:8
    ds_read_b64_tr_b16 v[166:167], v12 offset:2056
    ds_read_b64_tr_b16 v[168:169], v12 offset:16384
    ds_read_b64_tr_b16 v[170:171], v12 offset:18432
    ds_read_b64_tr_b16 v[172:173], v12 offset:16392
    ds_read_b64_tr_b16 v[174:175], v12 offset:18440
    ds_read_b64_tr_b16 v[176:177], v12 offset:32768
    ds_read_b64_tr_b16 v[178:179], v12 offset:34816
    ds_read_b64_tr_b16 v[180:181], v12 offset:32776
    ds_read_b64_tr_b16 v[182:183], v12 offset:34824
    s_add_u32 s96, s10, s35
    s_addc_u32 s97, s11, 0
    s_mov_b32 s98, 2048000
    s_mov_b32 s99, 0x20000
    v_lshrrev_b32 v2, 4, v0
    v_and_b32 v3, 15, v0
    v_lshrrev_b32 v4, 3, v3
    v_lshlrev_b32 v4, 12, v4
    v_lshl_add_u32 v4, v2, 7, v4
    v_and_b32 v14, 7, v3
    v_lshl_add_u32 v4, v14, 4, v4
    s_lshl_b32 s88, s29, 18
    s_lshl_b32 s89, s28, 15
    s_add_u32 s88, s88, s89
    s_add_u32 s89, s88, 8192
    s_add_u32 s91, s88, 16384
    s_add_u32 s92, s88, 24576
    s_mov_b32 s48, 0xc038aa3b
    s_mov_b32 s49, 0xc038aa3b
    s_mov_b32 s50, 0xbfb8aa3b
    s_mov_b32 s51, 0xbfb8aa3b
    s_mov_b32 s52, 1.0
    s_mov_b32 s53, 1.0
    s_mov_b32 s43, 0x42700000
    v_mul_u32_u24 v9, 528, v2
    v_lshl_add_u32 v9, v3, 4, v9
    v_add_u32 v9, 131072, v9
    v_mul_u32_u24 v11, 528, v6
    v_lshl_add_u32 v11, v7, 4, v11
    v_add_u32 v11, 131072, v11
    v_lshlrev_b32 v8, 3, v6
    s_add_u32 s44, s31, s28
    v_add_u32 v8, s44, v8
    v_lshlrev_b32 v8, 11, v8
    s_lshl_b32 s44, s33, 9
    s_lshl_b32 s45, s30, 6
    s_add_u32 s44, s44, s45
    v_add_u32 v8, s44, v8
    v_lshl_add_u32 v8, v7, 4, v8
    v_mov_b32 v14, 0xc2700000
    s_lshl_b32 s44, s29, 3
    s_add_u32 s44, s44, s28
    s_lshl_b32 s44, s44, 7
    s_add_u32 s44, s44, 17891328
    v_mov_b32 v84, s44
    v_and_b32 v85, 7, v5
    s_lshl_b32 s44, s29, 10
    s_add_u32 s44, s44, 17891328
    v_lshl_add_u32 v85, v85, 7, s44
    v_mov_b32 v15, s47
    s_barrier
    s_cmp_lg_u32 s30, 0
    s_cbranch_scc1 L_nofl
    s_mov_b64 exec, 1
    s_cmp_eq_u32 s94, 1
    s_cbranch_scc1 L_ffast
    global_store_dword v84, v15, s[14:15] sc1
    s_branch L_fdone
L_ffast:
    global_store_dword v84, v15, s[14:15]
L_fdone:
    s_mov_b64 exec, -1
    global_load_dword v87, v85, s[14:15] sc1
L_nofl:
    ds_read_b64_tr_b16 v[144:145], v10 offset:32768
    ds_read_b64_tr_b16 v[146:147], v10 offset:34816
    ds_read_b64_tr_b16 v[148:149], v10 offset:32776
    ds_read_b64_tr_b16 v[150:151], v10 offset:34824
    ds_read_b64_tr_b16 v[152:153], v10 offset:49152
    ds_read_b64_tr_b16 v[154:155], v10 offset:51200
    ds_read_b64_tr_b16 v[156:157], v10 offset:49160
    ds_read_b64_tr_b16 v[158:159], v10 offset:51208
    ds_read_b64_tr_b16 v[184:185], v12 offset:49152
    ds_read_b64_tr_b16 v[186:187], v12 offset:51200
    ds_read_b64_tr_b16 v[188:189], v12 offset:49160
    ds_read_b64_tr_b16 v[190:191], v12 offset:51208
    s_cmp_lg_u32 s30, 0
    s_cbranch_scc1 L_hwait
    s_mov_b32 s46, 0x100000
    s_branch L_hchk
L_hspin:
    global_load_dword v87, v85, s[14:15] sc1
L_hchk:
    s_waitcnt vmcnt(0)
    v_cmp_eq_u32 vcc, s47, v87
    s_sub_u32 s46, s46, 1
    s_cmp_eq_u32 s46, 0
    s_cbranch_scc1 L_hwait
    s_cmp_eq_u64 vcc, -1
    s_cbranch_scc0 L_hspin
L_hwait:
    s_waitcnt lgkmcnt(0)
    s_barrier
    buffer_load_dwordx4 v[16:19], v4, s[24:27], s88 offen sc1
    buffer_load_dwordx4 v[20:23], v4, s[24:27], s91 offen sc1
    buffer_load_dwordx4 v[24:27], v4, s[24:27], s89 offen sc1
    buffer_load_dwordx4 v[28:31], v4, s[24:27], s92 offen sc1
    s_waitcnt vmcnt(2)
    v_lshlrev_b32 v40, 16, v16
    v_and_b32 v41, s36, v16
    v_lshlrev_b32 v42, 16, v20
    v_and_b32 v43, s36, v20
    v_lshlrev_b32 v52, 16, v17
    v_and_b32 v53, s36, v17
    v_lshlrev_b32 v54, 16, v21
    v_and_b32 v55, s36, v21
    v_pk_mul_f32 v[40:41], v[40:41], s[48:49]
    v_pk_mul_f32 v[42:43], v[42:43], s[50:51]
    v_pk_mul_f32 v[52:53], v[52:53], s[48:49]
    v_pk_mul_f32 v[54:55], v[54:55], s[50:51]
    v_med3_f32 v40, v40, s43, v14
    v_med3_f32 v41, v41, s43, v14
    v_med3_f32 v52, v52, s43, v14
    v_med3_f32 v53, v53, s43, v14
    v_exp_f32 v42, v42
    v_exp_f32 v43, v43
    v_exp_f32 v54, v54
    v_exp_f32 v55, v55
    v_exp_f32 v40, v40
    v_exp_f32 v41, v41
    v_exp_f32 v52, v52
    v_exp_f32 v53, v53
    v_pk_add_f32 v[42:43], v[42:43], s[52:53]
    v_pk_add_f32 v[54:55], v[54:55], s[52:53]
    v_pk_add_f32 v[44:45], v[40:41], s[52:53]
    v_pk_add_f32 v[40:41], v[40:41], s[52:53] neg_lo:[1,0] neg_hi:[1,0]
    v_pk_add_f32 v[56:57], v[52:53], s[52:53]
    v_pk_add_f32 v[52:53], v[52:53], s[52:53] neg_lo:[1,0] neg_hi:[1,0]
    v_pk_mul_f32 v[44:45], v[44:45], v[42:43]
    v_pk_mul_f32 v[56:57], v[56:57], v[54:55]
    v_rcp_f32 v44, v44
    v_rcp_f32 v45, v45
    v_rcp_f32 v56, v56
    v_rcp_f32 v57, v57
    s_nop 0
    v_pk_mul_f32 v[40:41], v[40:41], v[44:45]
    v_pk_mul_f32 v[52:53], v[52:53], v[56:57]
    v_cvt_pk_bf16_f32 v32, v40, v41
    v_cvt_pk_bf16_f32 v33, v52, v53
    v_lshlrev_b32 v40, 16, v18
    v_and_b32 v41, s36, v18
    v_lshlrev_b32 v42, 16, v22
    v_and_b32 v43, s36, v22
    v_lshlrev_b32 v52, 16, v19
    v_and_b32 v53, s36, v19
    v_lshlrev_b32 v54, 16, v23
    v_and_b32 v55, s36, v23
    v_pk_mul_f32 v[40:41], v[40:41], s[48:49]
    v_pk_mul_f32 v[42:43], v[42:43], s[50:51]
    v_pk_mul_f32 v[52:53], v[52:53], s[48:49]
    v_pk_mul_f32 v[54:55], v[54:55], s[50:51]
    v_med3_f32 v40, v40, s43, v14
    v_med3_f32 v41, v41, s43, v14
    v_med3_f32 v52, v52, s43, v14
    v_med3_f32 v53, v53, s43, v14
    v_exp_f32 v42, v42
    v_exp_f32 v43, v43
    v_exp_f32 v54, v54
    v_exp_f32 v55, v55
    v_exp_f32 v40, v40
    v_exp_f32 v41, v41
    v_exp_f32 v52, v52
    v_exp_f32 v53, v53
    v_pk_add_f32 v[42:43], v[42:43], s[52:53]
    v_pk_add_f32 v[54:55], v[54:55], s[52:53]
    v_pk_add_f32 v[44:45], v[40:41], s[52:53]
    v_pk_add_f32 v[40:41], v[40:41], s[52:53] neg_lo:[1,0] neg_hi:[1,0]
    v_pk_add_f32 v[56:57], v[52:53], s[52:53]
    v_pk_add_f32 v[52:53], v[52:53], s[52:53] neg_lo:[1,0] neg_hi:[1,0]
    v_pk_mul_f32 v[44:45], v[44:45], v[42:43]
    v_pk_mul_f32 v[56:57], v[56:57], v[54:55]
    v_rcp_f32 v44, v44
    v_rcp_f32 v45, v45
    v_rcp_f32 v56, v56
    v_rcp_f32 v57, v57
    s_nop 0
    v_pk_mul_f32 v[40:41], v[40:41], v[44:45]
    v_pk_mul_f32 v[52:53], v[52:53], v[56:57]
    v_cvt_pk_bf16_f32 v34, v40, v41
    v_cvt_pk_bf16_f32 v35, v52, v53
    ds_write_b128 v9, v[32:35] offset:0
    s_waitcnt vmcnt(0)
    v_lshlrev_b32 v40, 16, v24
    v_and_b32 v41, s36, v24
    v_lshlrev_b32 v42, 16, v28
    v_and_b32 v43, s36, v28
    v_lshlrev_b32 v52, 16, v25
    v_and_b32 v53, s36, v25
    v_lshlrev_b32 v54, 16, v29
    v_and_b32 v55, s36, v29
    v_pk_mul_f32 v[40:41], v[40:41], s[48:49]
    v_pk_mul_f32 v[42:43], v[42:43], s[50:51]
    v_pk_mul_f32 v[52:53], v[52:53], s[48:49]
    v_pk_mul_f32 v[54:55], v[54:55], s[50:51]
    v_med3_f32 v40, v40, s43, v14
    v_med3_f32 v41, v41, s43, v14
    v_med3_f32 v52, v52, s43, v14
    v_med3_f32 v53, v53, s43, v14
    v_exp_f32 v42, v42
    v_exp_f32 v43, v43
    v_exp_f32 v54, v54
    v_exp_f32 v55, v55
    v_exp_f32 v40, v40
    v_exp_f32 v41, v41
    v_exp_f32 v52, v52
    v_exp_f32 v53, v53
    v_pk_add_f32 v[42:43], v[42:43], s[52:53]
    v_pk_add_f32 v[54:55], v[54:55], s[52:53]
    v_pk_add_f32 v[44:45], v[40:41], s[52:53]
    v_pk_add_f32 v[40:41], v[40:41], s[52:53] neg_lo:[1,0] neg_hi:[1,0]
    v_pk_add_f32 v[56:57], v[52:53], s[52:53]
    v_pk_add_f32 v[52:53], v[52:53], s[52:53] neg_lo:[1,0] neg_hi:[1,0]
    v_pk_mul_f32 v[44:45], v[44:45], v[42:43]
    v_pk_mul_f32 v[56:57], v[56:57], v[54:55]
    v_rcp_f32 v44, v44
    v_rcp_f32 v45, v45
    v_rcp_f32 v56, v56
    v_rcp_f32 v57, v57
    s_nop 0
    v_pk_mul_f32 v[40:41], v[40:41], v[44:45]
    v_pk_mul_f32 v[52:53], v[52:53], v[56:57]
    v_cvt_pk_bf16_f32 v36, v40, v41
    v_cvt_pk_bf16_f32 v37, v52, v53
    v_lshlrev_b32 v40, 16, v26
    v_and_b32 v41, s36, v26
    v_lshlrev_b32 v42, 16, v30
    v_and_b32 v43, s36, v30
    v_lshlrev_b32 v52, 16, v27
    v_and_b32 v53, s36, v27
    v_lshlrev_b32 v54, 16, v31
    v_and_b32 v55, s36, v31
    v_pk_mul_f32 v[40:41], v[40:41], s[48:49]
    v_pk_mul_f32 v[42:43], v[42:43], s[50:51]
    v_pk_mul_f32 v[52:53], v[52:53], s[48:49]
    v_pk_mul_f32 v[54:55], v[54:55], s[50:51]
    v_med3_f32 v40, v40, s43, v14
    v_med3_f32 v41, v41, s43, v14
    v_med3_f32 v52, v52, s43, v14
    v_med3_f32 v53, v53, s43, v14
    v_exp_f32 v42, v42
    v_exp_f32 v43, v43
    v_exp_f32 v54, v54
    v_exp_f32 v55, v55
    v_exp_f32 v40, v40
    v_exp_f32 v41, v41
    v_exp_f32 v52, v52
    v_exp_f32 v53, v53
    v_pk_add_f32 v[42:43], v[42:43], s[52:53]
    v_pk_add_f32 v[54:55], v[54:55], s[52:53]
    v_pk_add_f32 v[44:45], v[40:41], s[52:53]
    v_pk_add_f32 v[40:41], v[40:41], s[52:53] neg_lo:[1,0] neg_hi:[1,0]
    v_pk_add_f32 v[56:57], v[52:53], s[52:53]
    v_pk_add_f32 v[52:53], v[52:53], s[52:53] neg_lo:[1,0] neg_hi:[1,0]
    v_pk_mul_f32 v[44:45], v[44:45], v[42:43]
    v_pk_mul_f32 v[56:57], v[56:57], v[54:55]
    v_rcp_f32 v44, v44
    v_rcp_f32 v45, v45
    v_rcp_f32 v56, v56
    v_rcp_f32 v57, v57
    s_nop 0
    v_pk_mul_f32 v[40:41], v[40:41], v[44:45]
    v_pk_mul_f32 v[52:53], v[52:53], v[56:57]
    v_cvt_pk_bf16_f32 v38, v40, v41
    v_cvt_pk_bf16_f32 v39, v52, v53
    ds_write_b128 v9, v[36:39] offset:256
    s_waitcnt lgkmcnt(0)
    s_barrier
    ds_read_b128 v[192:195], v11 offset:0
    ds_read_b128 v[196:199], v11 offset:8448
    ds_read_b128 v[200:203], v11 offset:64
    ds_read_b128 v[204:207], v11 offset:8512
    ds_read_b128 v[208:211], v11 offset:128
    ds_read_b128 v[212:215], v11 offset:8576
    ds_read_b128 v[216:219], v11 offset:192
    ds_read_b128 v[220:223], v11 offset:8640
    s_waitcnt lgkmcnt(7)
    v_mfma_f32_16x16x32_bf16 v[64:67], v[128:131], v[192:195], 0
    s_waitcnt lgkmcnt(6)
    v_mfma_f32_16x16x32_bf16 v[72:75], v[128:131], v[196:199], 0
    v_mfma_f32_16x16x32_bf16 v[68:71], v[132:135], v[192:195], 0
    v_mfma_f32_16x16x32_bf16 v[76:79], v[132:135], v[196:199], 0
    ds_read_b128 v[192:195], v11 offset:256
    ds_read_b128 v[196:199], v11 offset:8704
    s_waitcnt lgkmcnt(7)
    v_mfma_f32_16x16x32_bf16 v[64:67], v[136:139], v[200:203], v[64:67]
    s_waitcnt lgkmcnt(6)
    v_mfma_f32_16x16x32_bf16 v[72:75], v[136:139], v[204:207], v[72:75]
    v_mfma_f32_16x16x32_bf16 v[68:71], v[140:143], v[200:203], v[68:71]
    v_mfma_f32_16x16x32_bf16 v[76:79], v[140:143], v[204:207], v[76:79]
    ds_read_b128 v[200:203], v11 offset:320
    ds_read_b128 v[204:207], v11 offset:8768
    s_waitcnt lgkmcnt(7)
    v_mfma_f32_16x16x32_bf16 v[64:67], v[144:147], v[208:211], v[64:67]
    s_waitcnt lgkmcnt(6)
    v_mfma_f32_16x16x32_bf16 v[72:75], v[144:147], v[212:215], v[72:75]
    v_mfma_f32_16x16x32_bf16 v[68:71], v[148:151], v[208:211], v[68:71]
    v_mfma_f32_16x16x32_bf16 v[76:79], v[148:151], v[212:215], v[76:79]
    ds_read_b128 v[208:211], v11 offset:384
    ds_read_b128 v[212:215], v11 offset:8832
    s_waitcnt lgkmcnt(7)
    v_mfma_f32_16x16x32_bf16 v[64:67], v[152:155], v[216:219], v[64:67]
    s_waitcnt lgkmcnt(6)
    v_mfma_f32_16x16x32_bf16 v[72:75], v[152:155], v[220:223], v[72:75]
    v_mfma_f32_16x16x32_bf16 v[68:71], v[156:159], v[216:219], v[68:71]
    v_mfma_f32_16x16x32_bf16 v[76:79], v[156:159], v[220:223], v[76:79]
    ds_read_b128 v[216:219], v11 offset:448
    ds_read_b128 v[220:223], v11 offset:8896
    s_waitcnt lgkmcnt(7)
    v_mfma_f32_16x16x32_bf16 v[64:67], v[160:163], v[192:195], v[64:67]
    s_waitcnt lgkmcnt(6)
    v_mfma_f32_16x16x32_bf16 v[72:75], v[160:163], v[196:199], v[72:75]
    v_mfma_f32_16x16x32_bf16 v[68:71], v[164:167], v[192:195], v[68:71]
    v_mfma_f32_16x16x32_bf16 v[76:79], v[164:167], v[196:199], v[76:79]
    s_waitcnt lgkmcnt(5)
    v_mfma_f32_16x16x32_bf16 v[64:67], v[168:171], v[200:203], v[64:67]
    s_waitcnt lgkmcnt(4)
    v_mfma_f32_16x16x32_bf16 v[72:75], v[168:171], v[204:207], v[72:75]
    v_mfma_f32_16x16x32_bf16 v[68:71], v[172:175], v[200:203], v[68:71]
    v_mfma_f32_16x16x32_bf16 v[76:79], v[172:175], v[204:207], v[76:79]
    s_waitcnt lgkmcnt(3)
    v_mfma_f32_16x16x32_bf16 v[64:67], v[176:179], v[208:211], v[64:67]
    s_waitcnt lgkmcnt(2)
    v_mfma_f32_16x16x32_bf16 v[72:75], v[176:179], v[212:215], v[72:75]
    v_mfma_f32_16x16x32_bf16 v[68:71], v[180:183], v[208:211], v[68:71]
    v_mfma_f32_16x16x32_bf16 v[76:79], v[180:183], v[212:215], v[76:79]
    s_waitcnt lgkmcnt(1)
    v_mfma_f32_16x16x32_bf16 v[64:67], v[184:187], v[216:219], v[64:67]
    s_waitcnt lgkmcnt(0)
    v_mfma_f32_16x16x32_bf16 v[72:75], v[184:187], v[220:223], v[72:75]
    v_mfma_f32_16x16x32_bf16 v[68:71], v[188:191], v[216:219], v[68:71]
    v_mfma_f32_16x16x32_bf16 v[76:79], v[188:191], v[220:223], v[76:79]
    s_nop 7
    s_nop 1
    v_cvt_pk_bf16_f32 v16, v64, v65
    v_cvt_pk_bf16_f32 v17, v66, v67
    v_cvt_pk_bf16_f32 v18, v68, v69
    v_cvt_pk_bf16_f32 v19, v70, v71
    v_cvt_pk_bf16_f32 v20, v72, v73
    v_cvt_pk_bf16_f32 v21, v74, v75
    v_cvt_pk_bf16_f32 v22, v76, v77
    v_cvt_pk_bf16_f32 v23, v78, v79
    buffer_store_dwordx4 v[16:19], v8, s[96:99], 0 offen offset:0 nt
    buffer_store_dwordx4 v[20:23], v8, s[96:99], 0 offen offset:1024 nt
L_end:
    s_endpgm
.section .rodata,"a"
.p2align 6
.amdhsa_kernel standalone__autoregressive_conv_wavenet__speech_kernel
  .amdhsa_next_free_vgpr 251
  .amdhsa_next_free_sgpr 102
  .amdhsa_accum_offset 252
  .amdhsa_group_segment_fixed_size 0
  .amdhsa_kernarg_size 48
  .amdhsa_user_sgpr_count 2
  .amdhsa_user_sgpr_kernarg_segment_ptr 1
  .amdhsa_system_sgpr_workgroup_id_x 1
.end_amdhsa_kernel
```
